```python
import torch

def _softmax(x, axis=-1):
    return torch.softmax(x, dim=axis)
def _gelu(x):
    return torch.nn.functional.gelu(x, approximate="tanh")
def _silu(x):
    return torch.nn.functional.silu(x)
def _sigmoid(x):
    return torch.sigmoid(x)
def _layernorm(x, axis=-1, eps=1e-5):
    m = x.mean(dim=axis, keepdim=True)
    v = x.var(dim=axis, keepdim=True, unbiased=False)
    return (x - m) / torch.sqrt(v + eps)
def _scatter_add(tgt, idx, src, axis=0):
    return tgt.clone().index_add_(axis, idx, src)
def _segment_sum(src, seg, n):
    out = torch.zeros((n,) + src.shape[1:], dtype=src.dtype)
    return out.index_add_(0, seg, src)
def _pad(x, pw):
    flat = tuple(v for pair in reversed(pw) for v in pair)
    return torch.nn.functional.pad(x, flat)

kernel_name = 'gated_mix__spectral_fnet__swiglu_ffn__prompt'

def setup_inputs():

    _w = (lambda a: (lambda t: t.to(torch.bfloat16) if t.is_floating_point() else t)(torch.as_tensor(a)))
    def _A_setup():
        B, S, D = 1, 2048, 512
        ns = torch.arange(S)[:, None] * torch.arange(S)[None, :]
        nd = torch.arange(D)[:, None] * torch.arange(D)[None, :]
        Ws_re = torch.cos(-2.0 * torch.pi * ns / S).to(float)
        Ws_im = torch.sin(-2.0 * torch.pi * ns / S).to(float)
        Wd_re = torch.cos(-2.0 * torch.pi * nd / D).to(float)
        Wd_im = torch.sin(-2.0 * torch.pi * nd / D).to(float)
        return {
            "x": _w((lambda *s: torch.randn(*s, dtype=torch.bfloat16) * 0.05)(B, S, D)),
            "dft_seq_re": _w(Ws_re),
            "dft_seq_im": _w(Ws_im),
            "dft_hid_re": _w(Wd_re),
            "dft_hid_im": _w(Wd_im),
        }
    _A_in = _A_setup()

    def _B_setup():
        B, S, D, F = 1, 2048, 512, 1792
        return {
            "x": _w((lambda *s: torch.randn(*s, dtype=torch.bfloat16) * 0.05)(B, S, D)),
            "w_gate": _w((lambda *s: torch.randn(*s, dtype=torch.bfloat16) * 0.8)(D, F)),
            "w_up": _w((lambda *s: torch.randn(*s, dtype=torch.bfloat16) * 0.8)(D, F)),
            "w_down": _w((lambda *s: torch.randn(*s, dtype=torch.bfloat16) * 0.8)(F, D)),
        }
    _B_in = _B_setup()

    return {
        "A_x": _A_in["x"],
        "A_dft_seq_re": _A_in["dft_seq_re"],
        "A_dft_seq_im": _A_in["dft_seq_im"],
        "A_dft_hid_re": _A_in["dft_hid_re"],
        "A_dft_hid_im": _A_in["dft_hid_im"],
        "B_x": _B_in["x"],
        "B_w_gate": _B_in["w_gate"],
        "B_w_up": _B_in["w_up"],
        "B_w_down": _B_in["w_down"],
        "gate_w": _w((lambda *s: torch.randn(*s, dtype=torch.bfloat16) * 0.05)(512) * 16.0),
    }

def reference(A_x, A_dft_seq_re, A_dft_seq_im, A_dft_hid_re, A_dft_hid_im, B_x, B_w_gate, B_w_up, B_w_down, gate_w):
    def _A_ref(x, dft_seq_re, dft_seq_im, dft_hid_re, dft_hid_im):
        a = torch.einsum("bsd,ed->bse", x, dft_hid_re)
        b = torch.einsum("bsd,ed->bse", x, dft_hid_im)
        y = torch.einsum("ts,bse->bte", dft_seq_re, a) - torch.einsum("ts,bse->bte", dft_seq_im, b)
        return y

    def _B_ref(x, w_gate, w_up, w_down):
        g = _silu(x @ w_gate)
        u = x @ w_up
        return (g * u) @ w_down

    x = A_x
    g = _sigmoid((x * gate_w).sum(-1, keepdims=True))
    a = _A_ref(x, A_dft_seq_re, A_dft_seq_im, A_dft_hid_re, A_dft_hid_im)
    b = _B_ref(x, B_w_gate, B_w_up, B_w_down)
    return g * a + (1 - g) * b
```

```asm
; @launch grid=(256,1,1) block=(512,1,1) lds=163840
.amdgcn_target "amdgcn-amd-amdhsa--gfx950"
.text
.globl gated_mix__spectral_fnet__swiglu_ffn__prompt_kernel
.p2align 8
.type gated_mix__spectral_fnet__swiglu_ffn__prompt_kernel,@function
gated_mix__spectral_fnet__swiglu_ffn__prompt_kernel:
    s_cmp_ge_u32 s2, 256
    s_cbranch_scc1 k1_exit
    s_load_dwordx8 s[4:11], s[0:1], 0
    s_load_dwordx2 s[12:13], s[0:1], 32
    s_load_dwordx4 s[16:19], s[0:1], 48
    s_load_dwordx2 s[14:15], s[0:1], 64
    s_load_dwordx2 s[20:21], s[0:1], 72
    s_load_dwordx2 s[22:23], s[0:1], 96
    s_load_dwordx4 s[64:67], s[0:1], 80
    v_lshrrev_b32 v1, 6, v0
    s_and_b32 s26, s2, 7
    v_readfirstlane_b32 s3, v1
    s_lshr_b32 s27, s2, 3
    s_and_b32 s24, s27, 7
    s_and_b32 s28, s26, 1
    s_lshl_b32 s28, s28, 3
    s_add_u32 s24, s24, s28
    s_lshr_b32 s25, s27, 3
    s_lshr_b32 s28, s26, 1
    s_lshl_b32 s28, s28, 2
    s_add_u32 s25, s25, s28
    s_and_b32 s77, s26, 6
    s_andn2_b32 s28, 1, s26
    s_lshl_b32 s28, s28, 3
    s_add_u32 s77, s77, s28
    s_lshr_b32 s28, s27, 4
    s_add_u32 s77, s77, s28
    s_and_b32 s28, s27, 8
    s_lshl_b32 s28, s28, 3
    s_add_u32 s76, s77, s28
    s_and_b32 s75, s27, 7
    s_xor_b32 s25, s25, 15
    s_mul_i32 s101, s75, 7
    s_lshr_b32 s28, s27, 3
    s_mul_i32 s28, s28, 14
    s_add_u32 s101, s101, s28
    s_lshr_b32 s101, s101, 2
    s_sub_u32 s28, s101, 14
    s_cselect_b32 s101, s101, s28
    s_mov_b32 s30, s25
    s_mov_b32 s98, s76
    s_lshl_b32 s99, s77, 9
    s_add_u32 s99, s99, 10493952
    s_waitcnt lgkmcnt(0)
    s_cmp_ge_u32 s25, 14
    s_cbranch_scc1 k1_dft
    s_cmp_ge_u32 s3, 4
    s_cbranch_scc0 k1_ffn_c
    s_sub_u32 s3, s3, 4
    s_mov_b32 s76, s75
    s_mov_b32 s32, s4
    s_and_b32 s33, s5, 0xffff
    s_mov_b32 s34, 0x200000
    s_mov_b32 s35, 0x20000
    s_mov_b32 s36, s16
    s_and_b32 s37, s17, 0xffff
    s_mov_b32 s38, 0x1c0000
    s_mov_b32 s39, 0x20000
    s_mov_b32 s40, s18
    s_and_b32 s41, s19, 0xffff
    s_mov_b32 s42, 0x1c0000
    s_mov_b32 s43, 0x20000
    v_and_b32 v1, 63, v0
    s_and_b32 s26, s3, 1
    s_lshl_b32 s26, s26, 3
    s_lshr_b32 s27, s3, 1
    v_lshrrev_b32 v3, 3, v1
    v_add_u32 v3, s26, v3
    v_lshrrev_b32 v4, 1, v3
    v_and_b32 v5, 7, v1
    v_xor_b32 v4, v4, v5
    v_lshlrev_b32 v4, 4, v4
    v_lshlrev_b32 v5, 7, v3
    s_lshl_b32 s27, s27, 4
    s_add_u32 s27, s27, s24
    v_add_u32 v5, s27, v5
    v_lshl_add_u32 v2, v5, 10, v4
    v_lshrrev_b32 v3, 4, v1
    s_lshr_b32 s26, s3, 1
    s_lshl_b32 s26, s26, 2
    v_or_b32 v4, s26, v3
    v_lshlrev_b32 v4, 1, v4
    v_and_b32 v5, 15, v1
    v_xor_b32 v4, v4, v5
    v_lshlrev_b32 v4, 4, v4
    s_lshl_b32 s26, s3, 2
    v_add_u32 v6, s26, v3
    v_mul_u32_u24 v7, 3584, v6
    v_add_u32 v7, v7, v4
    s_lshl_b32 s26, s25, 8
    v_add_u32 v7, s26, v7
    s_lshl_b32 s28, s3, 10
    s_mul_i32 s72, s24, 1
    s_mul_i32 s73, s30, 2
    s_add_u32 s72, s72, s73
    s_and_b32 s72, s72, 0
    s_add_u32 s73, s72, 0
    s_and_b32 s73, s73, 7
    s_lshl_b32 s74, s73, 7
    s_mul_i32 s75, s73, 229376
    s_add_u32 m0, s28, 0
    s_add_u32 s29, s74, 0
    buffer_load_dwordx4 v2, s[32:35], s29 offen lds
    s_add_u32 m0, s28, 4096
    s_add_u32 s29, s74, 32768
    buffer_load_dwordx4 v2, s[32:35], s29 offen lds
    s_add_u32 m0, s28, 8192
    s_add_u32 s29, s74, 65536
    buffer_load_dwordx4 v2, s[32:35], s29 offen lds
    s_add_u32 m0, s28, 12288
    s_add_u32 s29, s74, 98304
    buffer_load_dwordx4 v2, s[32:35], s29 offen lds
    s_add_u32 m0, s28, 16384
    s_add_u32 s29, s75, 0
    buffer_load_dwordx4 v7, s[36:39], s29 offen lds
    s_add_u32 m0, s28, 20480
    s_add_u32 s29, s75, 57344
    buffer_load_dwordx4 v7, s[36:39], s29 offen lds
    s_add_u32 m0, s28, 24576
    s_add_u32 s29, s75, 0
    buffer_load_dwordx4 v7, s[40:43], s29 offen lds
    s_add_u32 m0, s28, 28672
    s_add_u32 s29, s75, 57344
    buffer_load_dwordx4 v7, s[40:43], s29 offen lds
    s_add_u32 m0, s28, 32768
    s_add_u32 s29, s75, 114688
    buffer_load_dwordx4 v7, s[36:39], s29 offen lds
    s_add_u32 m0, s28, 36864
    s_add_u32 s29, s75, 172032
    buffer_load_dwordx4 v7, s[36:39], s29 offen lds
    s_add_u32 m0, s28, 40960
    s_add_u32 s29, s75, 114688
    buffer_load_dwordx4 v7, s[40:43], s29 offen lds
    s_add_u32 m0, s28, 45056
    s_add_u32 s29, s75, 172032
    buffer_load_dwordx4 v7, s[40:43], s29 offen lds
    s_add_u32 s73, s72, 1
    s_and_b32 s73, s73, 7
    s_lshl_b32 s74, s73, 7
    s_mul_i32 s75, s73, 229376
    s_add_u32 m0, s28, 49152
    s_add_u32 s29, s74, 0
    buffer_load_dwordx4 v2, s[32:35], s29 offen lds
    s_add_u32 m0, s28, 53248
    s_add_u32 s29, s74, 32768
    buffer_load_dwordx4 v2, s[32:35], s29 offen lds
    s_add_u32 m0, s28, 57344
    s_add_u32 s29, s74, 65536
    buffer_load_dwordx4 v2, s[32:35], s29 offen lds
    s_add_u32 m0, s28, 61440
    s_add_u32 s29, s74, 98304
    buffer_load_dwordx4 v2, s[32:35], s29 offen lds
    s_add_u32 m0, s28, 65536
    s_add_u32 s29, s75, 0
    buffer_load_dwordx4 v7, s[36:39], s29 offen lds
    s_add_u32 m0, s28, 69632
    s_add_u32 s29, s75, 57344
    buffer_load_dwordx4 v7, s[36:39], s29 offen lds
    s_add_u32 m0, s28, 73728
    s_add_u32 s29, s75, 0
    buffer_load_dwordx4 v7, s[40:43], s29 offen lds
    s_add_u32 m0, s28, 77824
    s_add_u32 s29, s75, 57344
    buffer_load_dwordx4 v7, s[40:43], s29 offen lds
    s_mov_b32 s68, s14
    s_and_b32 s69, s15, 0xffff
    s_mov_b32 s70, 0x1c0000
    s_mov_b32 s71, 0x20000
    v_lshrrev_b32 v5, 3, v1
    v_and_b32 v6, 6, v5
    v_and_b32 v3, 7, v1
    v_xor_b32 v6, v6, v3
    v_lshlrev_b32 v6, 4, v6
    s_lshl_b32 s26, s3, 3
    v_add_u32 v5, s26, v5
    v_lshl_add_u32 v11, v5, 10, v6
    s_lshl_b32 s26, s76, 7
    v_add_u32 v11, s26, v11
    v_lshlrev_b32 v48, 4, v1
    v_add_u32 v48, s28, v48
    v_add_u32 v49, 0x10000, v48
    v_add_u32 v50, 0x20000, v48
    s_mov_b32 s64, s66
    s_and_b32 s65, s67, 0xffff
    s_mov_b32 s66, 0x100
    s_mov_b32 s67, 0x20000
    v_mov_b32 v44, 0
    s_waitcnt vmcnt(12)
    s_barrier
    s_add_u32 m0, s28, 81920
    s_add_u32 s29, s75, 114688
    buffer_load_dwordx4 v7, s[36:39], s29 offen lds
    s_add_u32 m0, s28, 86016
    s_add_u32 s29, s75, 172032
    buffer_load_dwordx4 v7, s[36:39], s29 offen lds
    s_add_u32 m0, s28, 90112
    s_add_u32 s29, s75, 114688
    buffer_load_dwordx4 v7, s[40:43], s29 offen lds
    s_add_u32 m0, s28, 94208
    s_add_u32 s29, s75, 172032
    buffer_load_dwordx4 v7, s[40:43], s29 offen lds
    s_add_u32 s73, s72, 2
    s_and_b32 s73, s73, 7
    s_lshl_b32 s74, s73, 7
    s_mul_i32 s75, s73, 229376
    s_add_u32 m0, s28, 98304
    s_add_u32 s29, s74, 0
    buffer_load_dwordx4 v2, s[32:35], s29 offen lds
    s_add_u32 m0, s28, 102400
    s_add_u32 s29, s74, 32768
    buffer_load_dwordx4 v2, s[32:35], s29 offen lds
    s_add_u32 m0, s28, 106496
    s_add_u32 s29, s74, 65536
    buffer_load_dwordx4 v2, s[32:35], s29 offen lds
    s_add_u32 m0, s28, 110592
    s_add_u32 s29, s74, 98304
    buffer_load_dwordx4 v2, s[32:35], s29 offen lds
    s_add_u32 m0, s28, 114688
    s_add_u32 s29, s75, 0
    buffer_load_dwordx4 v7, s[36:39], s29 offen lds
    s_add_u32 m0, s28, 118784
    s_add_u32 s29, s75, 57344
    buffer_load_dwordx4 v7, s[36:39], s29 offen lds
    s_add_u32 m0, s28, 122880
    s_add_u32 s29, s75, 0
    buffer_load_dwordx4 v7, s[40:43], s29 offen lds
    s_add_u32 m0, s28, 126976
    s_add_u32 s29, s75, 57344
    buffer_load_dwordx4 v7, s[40:43], s29 offen lds
    s_waitcnt vmcnt(20)
    s_barrier
    s_add_u32 m0, s28, 131072
    s_add_u32 s29, s75, 114688
    buffer_load_dwordx4 v7, s[36:39], s29 offen lds
    s_add_u32 m0, s28, 135168
    s_add_u32 s29, s75, 172032
    buffer_load_dwordx4 v7, s[36:39], s29 offen lds
    s_add_u32 m0, s28, 139264
    s_add_u32 s29, s75, 114688
    buffer_load_dwordx4 v7, s[40:43], s29 offen lds
    s_add_u32 m0, s28, 143360
    s_add_u32 s29, s75, 172032
    buffer_load_dwordx4 v7, s[40:43], s29 offen lds
    s_add_u32 s73, s72, 3
    s_and_b32 s73, s73, 7
    s_lshl_b32 s74, s73, 7
    s_mul_i32 s75, s73, 229376
    s_add_u32 m0, s28, 147456
    s_add_u32 s29, s74, 0
    buffer_load_dwordx4 v2, s[32:35], s29 offen lds
    s_add_u32 m0, s28, 151552
    s_add_u32 s29, s74, 32768
    buffer_load_dwordx4 v2, s[32:35], s29 offen lds
    s_add_u32 m0, s28, 155648
    s_add_u32 s29, s74, 65536
    buffer_load_dwordx4 v2, s[32:35], s29 offen lds
    s_add_u32 m0, s28, 159744
    s_add_u32 s29, s74, 98304
    buffer_load_dwordx4 v2, s[32:35], s29 offen lds
    s_add_u32 m0, s28, 16384
    s_add_u32 s29, s75, 0
    buffer_load_dwordx4 v7, s[36:39], s29 offen lds
    s_add_u32 m0, s28, 20480
    s_add_u32 s29, s75, 57344
    buffer_load_dwordx4 v7, s[36:39], s29 offen lds
    s_add_u32 m0, s28, 24576
    s_add_u32 s29, s75, 0
    buffer_load_dwordx4 v7, s[40:43], s29 offen lds
    s_add_u32 m0, s28, 28672
    s_add_u32 s29, s75, 57344
    buffer_load_dwordx4 v7, s[40:43], s29 offen lds
    s_waitcnt vmcnt(24)
    s_barrier
    s_add_u32 m0, s28, 32768
    s_add_u32 s29, s75, 114688
    buffer_load_dwordx4 v7, s[36:39], s29 offen lds
    s_add_u32 m0, s28, 36864
    s_add_u32 s29, s75, 172032
    buffer_load_dwordx4 v7, s[36:39], s29 offen lds
    s_add_u32 m0, s28, 40960
    s_add_u32 s29, s75, 114688
    buffer_load_dwordx4 v7, s[40:43], s29 offen lds
    s_add_u32 m0, s28, 45056
    s_add_u32 s29, s75, 172032
    buffer_load_dwordx4 v7, s[40:43], s29 offen lds
    s_add_u32 s73, s72, 4
    s_and_b32 s73, s73, 7
    s_lshl_b32 s74, s73, 7
    s_mul_i32 s75, s73, 229376
    s_add_u32 m0, s28, 0
    s_add_u32 s29, s74, 0
    buffer_load_dwordx4 v2, s[32:35], s29 offen lds
    s_add_u32 m0, s28, 4096
    s_add_u32 s29, s74, 32768
    buffer_load_dwordx4 v2, s[32:35], s29 offen lds
    s_add_u32 m0, s28, 8192
    s_add_u32 s29, s74, 65536
    buffer_load_dwordx4 v2, s[32:35], s29 offen lds
    s_add_u32 m0, s28, 12288
    s_add_u32 s29, s74, 98304
    buffer_load_dwordx4 v2, s[32:35], s29 offen lds
    s_waitcnt vmcnt(28)
    s_barrier
    s_add_u32 m0, s28, 65536
    s_add_u32 s29, s75, 0
    buffer_load_dwordx4 v7, s[36:39], s29 offen lds
    s_add_u32 m0, s28, 69632
    s_add_u32 s29, s75, 57344
    buffer_load_dwordx4 v7, s[36:39], s29 offen lds
    s_add_u32 m0, s28, 73728
    s_add_u32 s29, s75, 0
    buffer_load_dwordx4 v7, s[40:43], s29 offen lds
    s_add_u32 m0, s28, 77824
    s_add_u32 s29, s75, 57344
    buffer_load_dwordx4 v7, s[40:43], s29 offen lds
    s_waitcnt vmcnt(24)
    s_barrier
    s_add_u32 m0, s28, 81920
    s_add_u32 s29, s75, 114688
    buffer_load_dwordx4 v7, s[36:39], s29 offen lds
    s_add_u32 m0, s28, 86016
    s_add_u32 s29, s75, 172032
    buffer_load_dwordx4 v7, s[36:39], s29 offen lds
    s_add_u32 m0, s28, 90112
    s_add_u32 s29, s75, 114688
    buffer_load_dwordx4 v7, s[40:43], s29 offen lds
    s_add_u32 m0, s28, 94208
    s_add_u32 s29, s75, 172032
    buffer_load_dwordx4 v7, s[40:43], s29 offen lds
    s_add_u32 s73, s72, 5
    s_and_b32 s73, s73, 7
    s_lshl_b32 s74, s73, 7
    s_mul_i32 s75, s73, 229376
    s_add_u32 m0, s28, 49152
    s_add_u32 s29, s74, 0
    buffer_load_dwordx4 v2, s[32:35], s29 offen lds
    s_add_u32 m0, s28, 53248
    s_add_u32 s29, s74, 32768
    buffer_load_dwordx4 v2, s[32:35], s29 offen lds
    s_add_u32 m0, s28, 57344
    s_add_u32 s29, s74, 65536
    buffer_load_dwordx4 v2, s[32:35], s29 offen lds
    s_add_u32 m0, s28, 61440
    s_add_u32 s29, s74, 98304
    buffer_load_dwordx4 v2, s[32:35], s29 offen lds
    s_waitcnt vmcnt(28)
    s_barrier
    s_add_u32 m0, s28, 114688
    s_add_u32 s29, s75, 0
    buffer_load_dwordx4 v7, s[36:39], s29 offen lds
    s_add_u32 m0, s28, 118784
    s_add_u32 s29, s75, 57344
    buffer_load_dwordx4 v7, s[36:39], s29 offen lds
    s_add_u32 m0, s28, 122880
    s_add_u32 s29, s75, 0
    buffer_load_dwordx4 v7, s[40:43], s29 offen lds
    s_add_u32 m0, s28, 126976
    s_add_u32 s29, s75, 57344
    buffer_load_dwordx4 v7, s[40:43], s29 offen lds
    s_waitcnt vmcnt(24)
    s_barrier
    s_add_u32 m0, s28, 131072
    s_add_u32 s29, s75, 114688
    buffer_load_dwordx4 v7, s[36:39], s29 offen lds
    s_add_u32 m0, s28, 135168
    s_add_u32 s29, s75, 172032
    buffer_load_dwordx4 v7, s[36:39], s29 offen lds
    s_add_u32 m0, s28, 139264
    s_add_u32 s29, s75, 114688
    buffer_load_dwordx4 v7, s[40:43], s29 offen lds
    s_add_u32 m0, s28, 143360
    s_add_u32 s29, s75, 172032
    buffer_load_dwordx4 v7, s[40:43], s29 offen lds
    s_add_u32 s73, s72, 6
    s_and_b32 s73, s73, 7
    s_lshl_b32 s74, s73, 7
    s_mul_i32 s75, s73, 229376
    s_add_u32 m0, s28, 98304
    s_add_u32 s29, s74, 0
    buffer_load_dwordx4 v2, s[32:35], s29 offen lds
    s_add_u32 m0, s28, 102400
    s_add_u32 s29, s74, 32768
    buffer_load_dwordx4 v2, s[32:35], s29 offen lds
    s_add_u32 m0, s28, 106496
    s_add_u32 s29, s74, 65536
    buffer_load_dwordx4 v2, s[32:35], s29 offen lds
    s_add_u32 m0, s28, 110592
    s_add_u32 s29, s74, 98304
    buffer_load_dwordx4 v2, s[32:35], s29 offen lds
    s_waitcnt vmcnt(28)
    s_barrier
    s_add_u32 m0, s28, 16384
    s_add_u32 s29, s75, 0
    buffer_load_dwordx4 v7, s[36:39], s29 offen lds
    s_add_u32 m0, s28, 20480
    s_add_u32 s29, s75, 57344
    buffer_load_dwordx4 v7, s[36:39], s29 offen lds
    s_add_u32 m0, s28, 24576
    s_add_u32 s29, s75, 0
    buffer_load_dwordx4 v7, s[40:43], s29 offen lds
    s_add_u32 m0, s28, 28672
    s_add_u32 s29, s75, 57344
    buffer_load_dwordx4 v7, s[40:43], s29 offen lds
    s_waitcnt vmcnt(24)
    s_barrier
    s_add_u32 m0, s28, 32768
    s_add_u32 s29, s75, 114688
    buffer_load_dwordx4 v7, s[36:39], s29 offen lds
    s_add_u32 m0, s28, 36864
    s_add_u32 s29, s75, 172032
    buffer_load_dwordx4 v7, s[36:39], s29 offen lds
    s_add_u32 m0, s28, 40960
    s_add_u32 s29, s75, 114688
    buffer_load_dwordx4 v7, s[40:43], s29 offen lds
    s_add_u32 m0, s28, 45056
    s_add_u32 s29, s75, 172032
    buffer_load_dwordx4 v7, s[40:43], s29 offen lds
    s_add_u32 s73, s72, 7
    s_and_b32 s73, s73, 7
    s_lshl_b32 s74, s73, 7
    s_mul_i32 s75, s73, 229376
    s_add_u32 m0, s28, 147456
    s_add_u32 s29, s74, 0
    buffer_load_dwordx4 v2, s[32:35], s29 offen lds
    s_add_u32 m0, s28, 151552
    s_add_u32 s29, s74, 32768
    buffer_load_dwordx4 v2, s[32:35], s29 offen lds
    s_add_u32 m0, s28, 155648
    s_add_u32 s29, s74, 65536
    buffer_load_dwordx4 v2, s[32:35], s29 offen lds
    s_add_u32 m0, s28, 159744
    s_add_u32 s29, s74, 98304
    buffer_load_dwordx4 v2, s[32:35], s29 offen lds
    s_waitcnt vmcnt(28)
    s_barrier
    s_add_u32 m0, s28, 65536
    s_add_u32 s29, s75, 0
    buffer_load_dwordx4 v7, s[36:39], s29 offen lds
    s_add_u32 m0, s28, 69632
    s_add_u32 s29, s75, 57344
    buffer_load_dwordx4 v7, s[36:39], s29 offen lds
    s_add_u32 m0, s28, 73728
    s_add_u32 s29, s75, 0
    buffer_load_dwordx4 v7, s[40:43], s29 offen lds
    s_add_u32 m0, s28, 77824
    s_add_u32 s29, s75, 57344
    buffer_load_dwordx4 v7, s[40:43], s29 offen lds
    s_waitcnt vmcnt(24)
    s_barrier
    s_add_u32 m0, s28, 81920
    s_add_u32 s29, s75, 114688
    buffer_load_dwordx4 v7, s[36:39], s29 offen lds
    s_add_u32 m0, s28, 86016
    s_add_u32 s29, s75, 172032
    buffer_load_dwordx4 v7, s[36:39], s29 offen lds
    s_add_u32 m0, s28, 90112
    s_add_u32 s29, s75, 114688
    buffer_load_dwordx4 v7, s[40:43], s29 offen lds
    s_add_u32 m0, s28, 94208
    s_add_u32 s29, s75, 172032
    buffer_load_dwordx4 v7, s[40:43], s29 offen lds
    s_waitcnt vmcnt(24)
    s_barrier
    s_add_u32 s62, s101, 8
    s_sub_u32 s63, s62, 14
    s_cselect_b32 s62, s62, s63
    s_lshl_b32 s62, s62, 17
    s_add_u32 m0, s28, 0
    s_add_u32 s29, s62, 0
    buffer_load_dwordx4 v11, s[68:71], s29 offen lds
    s_add_u32 m0, s28, 4096
    s_add_u32 s29, s62, 32768
    buffer_load_dwordx4 v11, s[68:71], s29 offen lds
    s_add_u32 m0, s28, 8192
    s_add_u32 s29, s62, 65536
    buffer_load_dwordx4 v11, s[68:71], s29 offen lds
    s_add_u32 m0, s28, 12288
    s_add_u32 s29, s62, 98304
    buffer_load_dwordx4 v11, s[68:71], s29 offen lds
    s_waitcnt vmcnt(20)
    s_barrier
    s_add_u32 s62, s101, 0
    s_sub_u32 s63, s62, 14
    s_cselect_b32 s62, s62, s63
    s_lshl_b32 s62, s62, 17
    s_add_u32 m0, s28, 131072
    s_add_u32 s29, s62, 0
    buffer_load_dwordx4 v11, s[68:71], s29 offen lds
    s_add_u32 m0, s28, 135168
    s_add_u32 s29, s62, 32768
    buffer_load_dwordx4 v11, s[68:71], s29 offen lds
    s_add_u32 m0, s28, 139264
    s_add_u32 s29, s62, 65536
    buffer_load_dwordx4 v11, s[68:71], s29 offen lds
    s_add_u32 m0, s28, 143360
    s_add_u32 s29, s62, 98304
    buffer_load_dwordx4 v11, s[68:71], s29 offen lds
    s_add_u32 s62, s101, 1
    s_sub_u32 s63, s62, 14
    s_cselect_b32 s62, s62, s63
    s_lshl_b32 s62, s62, 17
    s_add_u32 m0, s28, 49152
    s_add_u32 s29, s62, 0
    buffer_load_dwordx4 v11, s[68:71], s29 offen lds
    s_add_u32 m0, s28, 53248
    s_add_u32 s29, s62, 32768
    buffer_load_dwordx4 v11, s[68:71], s29 offen lds
    s_add_u32 m0, s28, 57344
    s_add_u32 s29, s62, 65536
    buffer_load_dwordx4 v11, s[68:71], s29 offen lds
    s_add_u32 m0, s28, 61440
    s_add_u32 s29, s62, 98304
    buffer_load_dwordx4 v11, s[68:71], s29 offen lds
    buffer_load_dwordx2 v[40:41], v44, s[64:67], 0 offen sc0 sc1
    s_mov_b32 s52, s22
    s_and_b32 s53, s23, 0xffff
    s_mov_b32 s54, 0xa04000
    s_mov_b32 s55, 0x20000
    s_mov_b32 s56, s20
    s_and_b32 s57, s21, 0xffff
    s_mov_b32 s58, 0x400
    s_mov_b32 s59, 0x20000
    v_lshlrev_b32 v9, 4, v1
    s_lshl_b32 s26, s30, 3
    s_lshl_b32 s27, s3, 1
    s_add_u32 s26, s26, s27
    s_lshl_b32 s26, s26, 4
    s_add_u32 s31, s26, s24
    s_lshl_b32 s26, s31, 10
    s_add_u32 s27, s26, 16384
    buffer_load_dwordx4 v[12:15], v9, s[56:59], 0 offen
    buffer_load_dwordx4 v[16:19], v9, s[32:35], s26 offen
    buffer_load_dwordx4 v[20:23], v9, s[32:35], s27 offen
    s_waitcnt vmcnt(28)
    s_barrier
    s_add_u32 s62, s101, 2
    s_sub_u32 s63, s62, 14
    s_cselect_b32 s62, s62, s63
    s_lshl_b32 s62, s62, 17
    s_add_u32 m0, s28, 16384
    s_add_u32 s29, s62, 0
    buffer_load_dwordx4 v11, s[68:71], s29 offen lds
    s_add_u32 m0, s28, 20480
    s_add_u32 s29, s62, 32768
    buffer_load_dwordx4 v11, s[68:71], s29 offen lds
    s_add_u32 m0, s28, 24576
    s_add_u32 s29, s62, 65536
    buffer_load_dwordx4 v11, s[68:71], s29 offen lds
    s_add_u32 m0, s28, 28672
    s_add_u32 s29, s62, 98304
    buffer_load_dwordx4 v11, s[68:71], s29 offen lds
    s_waitcnt vmcnt(24)
    s_barrier
    s_add_u32 s62, s101, 3
    s_sub_u32 s63, s62, 14
    s_cselect_b32 s62, s62, s63
    s_lshl_b32 s62, s62, 17
    s_add_u32 m0, s28, 32768
    s_add_u32 s29, s62, 0
    buffer_load_dwordx4 v11, s[68:71], s29 offen lds
    s_add_u32 m0, s28, 36864
    s_add_u32 s29, s62, 32768
    buffer_load_dwordx4 v11, s[68:71], s29 offen lds
    s_add_u32 m0, s28, 40960
    s_add_u32 s29, s62, 65536
    buffer_load_dwordx4 v11, s[68:71], s29 offen lds
    s_add_u32 m0, s28, 45056
    s_add_u32 s29, s62, 98304
    buffer_load_dwordx4 v11, s[68:71], s29 offen lds
    s_add_u32 s62, s101, 4
    s_sub_u32 s63, s62, 14
    s_cselect_b32 s62, s62, s63
    s_lshl_b32 s62, s62, 17
    s_add_u32 m0, s28, 98304
    s_add_u32 s29, s62, 0
    buffer_load_dwordx4 v11, s[68:71], s29 offen lds
    s_add_u32 m0, s28, 102400
    s_add_u32 s29, s62, 32768
    buffer_load_dwordx4 v11, s[68:71], s29 offen lds
    s_add_u32 m0, s28, 106496
    s_add_u32 s29, s62, 65536
    buffer_load_dwordx4 v11, s[68:71], s29 offen lds
    s_add_u32 m0, s28, 110592
    s_add_u32 s29, s62, 98304
    buffer_load_dwordx4 v11, s[68:71], s29 offen lds
    s_waitcnt vmcnt(28)
    s_barrier
    s_add_u32 s62, s101, 5
    s_sub_u32 s63, s62, 14
    s_cselect_b32 s62, s62, s63
    s_lshl_b32 s62, s62, 17
    s_add_u32 m0, s28, 65536
    s_add_u32 s29, s62, 0
    buffer_load_dwordx4 v11, s[68:71], s29 offen lds
    s_add_u32 m0, s28, 69632
    s_add_u32 s29, s62, 32768
    buffer_load_dwordx4 v11, s[68:71], s29 offen lds
    s_add_u32 m0, s28, 73728
    s_add_u32 s29, s62, 65536
    buffer_load_dwordx4 v11, s[68:71], s29 offen lds
    s_add_u32 m0, s28, 77824
    s_add_u32 s29, s62, 98304
    buffer_load_dwordx4 v11, s[68:71], s29 offen lds
    s_barrier
    s_add_u32 s62, s101, 6
    s_sub_u32 s63, s62, 14
    s_cselect_b32 s62, s62, s63
    s_lshl_b32 s62, s62, 17
    s_add_u32 m0, s28, 81920
    s_add_u32 s29, s62, 0
    buffer_load_dwordx4 v11, s[68:71], s29 offen lds
    s_add_u32 m0, s28, 86016
    s_add_u32 s29, s62, 32768
    buffer_load_dwordx4 v11, s[68:71], s29 offen lds
    s_add_u32 m0, s28, 90112
    s_add_u32 s29, s62, 65536
    buffer_load_dwordx4 v11, s[68:71], s29 offen lds
    s_add_u32 m0, s28, 94208
    s_add_u32 s29, s62, 98304
    buffer_load_dwordx4 v11, s[68:71], s29 offen lds
    s_add_u32 s62, s101, 7
    s_sub_u32 s63, s62, 14
    s_cselect_b32 s62, s62, s63
    s_lshl_b32 s62, s62, 17
    s_add_u32 m0, s28, 147456
    s_add_u32 s29, s62, 0
    buffer_load_dwordx4 v11, s[68:71], s29 offen lds
    s_add_u32 m0, s28, 151552
    s_add_u32 s29, s62, 32768
    buffer_load_dwordx4 v11, s[68:71], s29 offen lds
    s_add_u32 m0, s28, 155648
    s_add_u32 s29, s62, 65536
    buffer_load_dwordx4 v11, s[68:71], s29 offen lds
    s_add_u32 m0, s28, 159744
    s_add_u32 s29, s62, 98304
    buffer_load_dwordx4 v11, s[68:71], s29 offen lds
    s_waitcnt vmcnt(27)
    s_mov_b32 s27, 0x40000
nnf:
    v_cmp_ne_u64 vcc, 0, v[40:41]
    s_sub_u32 s27, s27, 1
    s_cbranch_scc1 nnf_d
    s_nop 3
    s_cbranch_vccnz nnf_d
    buffer_load_dwordx2 v[40:41], v44, s[64:67], 0 offen sc0 sc1
    s_waitcnt vmcnt(0)
    s_branch nnf
nnf_d:
    s_waitcnt vmcnt(24)
    v_lshlrev_b32 v24, 16, v12
    v_and_b32 v25, 0xffff0000, v12
    v_lshlrev_b32 v26, 16, v13
    v_and_b32 v27, 0xffff0000, v13
    v_lshlrev_b32 v28, 16, v14
    v_and_b32 v29, 0xffff0000, v14
    v_lshlrev_b32 v30, 16, v15
    v_and_b32 v31, 0xffff0000, v15
    v_lshlrev_b32 v32, 16, v16
    v_and_b32 v33, 0xffff0000, v16
    v_mul_f32 v32, v32, v24
    v_mul_f32 v33, v33, v25
    v_cvt_pk_bf16_f32 v32, v32, v33
    v_and_b32 v33, 0xffff0000, v32
    v_lshlrev_b32 v32, 16, v32
    v_add_f32 v34, v32, v33
    v_lshlrev_b32 v32, 16, v17
    v_and_b32 v33, 0xffff0000, v17
    v_mul_f32 v32, v32, v26
    v_mul_f32 v33, v33, v27
    v_cvt_pk_bf16_f32 v32, v32, v33
    v_and_b32 v33, 0xffff0000, v32
    v_lshlrev_b32 v32, 16, v32
    v_add_f32 v32, v32, v33
    v_add_f32 v34, v34, v32
    v_lshlrev_b32 v32, 16, v18
    v_and_b32 v33, 0xffff0000, v18
    v_mul_f32 v32, v32, v28
    v_mul_f32 v33, v33, v29
    v_cvt_pk_bf16_f32 v32, v32, v33
    v_and_b32 v33, 0xffff0000, v32
    v_lshlrev_b32 v32, 16, v32
    v_add_f32 v32, v32, v33
    v_add_f32 v34, v34, v32
    v_lshlrev_b32 v32, 16, v19
    v_and_b32 v33, 0xffff0000, v19
    v_mul_f32 v32, v32, v30
    v_mul_f32 v33, v33, v31
    v_cvt_pk_bf16_f32 v32, v32, v33
    v_and_b32 v33, 0xffff0000, v32
    v_lshlrev_b32 v32, 16, v32
    v_add_f32 v32, v32, v33
    v_add_f32 v34, v34, v32
    v_lshlrev_b32 v32, 16, v20
    v_and_b32 v33, 0xffff0000, v20
    v_mul_f32 v32, v32, v24
    v_mul_f32 v33, v33, v25
    v_cvt_pk_bf16_f32 v32, v32, v33
    v_and_b32 v33, 0xffff0000, v32
    v_lshlrev_b32 v32, 16, v32
    v_add_f32 v35, v32, v33
    v_lshlrev_b32 v32, 16, v21
    v_and_b32 v33, 0xffff0000, v21
    v_mul_f32 v32, v32, v26
    v_mul_f32 v33, v33, v27
    v_cvt_pk_bf16_f32 v32, v32, v33
    v_and_b32 v33, 0xffff0000, v32
    v_lshlrev_b32 v32, 16, v32
    v_add_f32 v32, v32, v33
    v_add_f32 v35, v35, v32
    v_lshlrev_b32 v32, 16, v22
    v_and_b32 v33, 0xffff0000, v22
    v_mul_f32 v32, v32, v28
    v_mul_f32 v33, v33, v29
    v_cvt_pk_bf16_f32 v32, v32, v33
    v_and_b32 v33, 0xffff0000, v32
    v_lshlrev_b32 v32, 16, v32
    v_add_f32 v32, v32, v33
    v_add_f32 v35, v35, v32
    v_lshlrev_b32 v32, 16, v23
    v_and_b32 v33, 0xffff0000, v23
    v_mul_f32 v32, v32, v30
    v_mul_f32 v33, v33, v31
    v_cvt_pk_bf16_f32 v32, v32, v33
    v_and_b32 v33, 0xffff0000, v32
    v_lshlrev_b32 v32, 16, v32
    v_add_f32 v32, v32, v33
    v_add_f32 v35, v35, v32
    s_nop 1
    v_add_f32_dpp v34, v34, v34 row_ror:8 row_mask:0xf bank_mask:0xf
    v_add_f32_dpp v35, v35, v35 row_ror:8 row_mask:0xf bank_mask:0xf
    s_nop 1
    v_add_f32_dpp v34, v34, v34 row_ror:4 row_mask:0xf bank_mask:0xf
    v_add_f32_dpp v35, v35, v35 row_ror:4 row_mask:0xf bank_mask:0xf
    s_nop 1
    v_add_f32_dpp v34, v34, v34 row_ror:2 row_mask:0xf bank_mask:0xf
    v_add_f32_dpp v35, v35, v35 row_ror:2 row_mask:0xf bank_mask:0xf
    s_nop 1
    v_add_f32_dpp v34, v34, v34 row_ror:1 row_mask:0xf bank_mask:0xf
    v_add_f32_dpp v35, v35, v35 row_ror:1 row_mask:0xf bank_mask:0xf
    s_nop 1
    v_readlane_b32 s60, v34, 16
    v_readlane_b32 s61, v34, 32
    v_readlane_b32 s62, v34, 48
    v_readlane_b32 s63, v35, 16
    v_readlane_b32 s64, v35, 32
    v_readlane_b32 s65, v35, 48
    s_nop 1
    v_add_f32 v34, s60, v34
    v_add_f32 v34, s61, v34
    v_add_f32 v34, s62, v34
    v_add_f32 v35, s63, v35
    v_add_f32 v35, s64, v35
    v_add_f32 v35, s65, v35
    v_cvt_pk_bf16_f32 v34, v34, v35
    v_and_b32 v35, 0xffff0000, v34
    v_lshlrev_b32 v34, 16, v34
    v_mul_f32 v34, 0xbfb8aa3b, v34
    v_mul_f32 v35, 0xbfb8aa3b, v35
    v_exp_f32 v34, v34
    v_exp_f32 v35, v35
    s_nop 0
    v_add_f32 v34, 1.0, v34
    v_add_f32 v35, 1.0, v35
    v_rcp_f32 v34, v34
    v_rcp_f32 v35, v35
    s_nop 0
    v_cvt_pk_bf16_f32 v34, v34, v35
    v_and_b32 v35, 0xffff0000, v34
    v_lshlrev_b32 v34, 16, v34
    s_lshl_b32 s26, s31, 2
    s_add_u32 s26, s26, 10485760
    v_mov_b32 v36, 0
    s_mov_b64 exec, 1
    buffer_store_dword v34, v36, s[52:55], s26 offen sc1
    buffer_store_dword v35, v36, s[52:55], s26 offen offset:64 sc1
    s_mov_b64 exec, -1
    s_lshl_b32 s26, s24, 9
    s_lshl_b32 s27, s25, 3
    s_add_u32 s26, s26, s27
    s_add_u32 s26, s26, 10493952
    s_waitcnt vmcnt(0)
    s_barrier
    s_cmp_lg_u32 s3, 0
    s_cbranch_scc1 nosigf
    s_mov_b64 exec, 1
    buffer_store_dwordx2 v[40:41], v44, s[52:55], s26 offen sc0 sc1
    s_mov_b64 exec, -1
nosigf:
    s_branch ld2
k1_dft:
    s_sub_u32 s25, s25, 14
    s_cmp_ge_u32 s3, 4
    s_cbranch_scc0 k1_dft_c
    s_sub_u32 s3, s3, 4
    s_mov_b32 s76, s75
    s_mov_b32 s32, s4
    s_and_b32 s33, s5, 0xffff
    s_mov_b32 s34, 0x200000
    s_mov_b32 s35, 0x20000
    s_mov_b32 s36, s10
    s_and_b32 s37, s11, 0xffff
    s_mov_b32 s38, 0x80000
    s_mov_b32 s39, 0x20000
    s_mov_b32 s40, s12
    s_and_b32 s41, s13, 0xffff
    s_mov_b32 s42, 0x80000
    s_mov_b32 s43, 0x20000
    s_mov_b32 s44, s6
    s_and_b32 s45, s7, 0xffff
    s_mov_b32 s46, 0x800000
    s_mov_b32 s47, 0x20000
    s_mov_b32 s48, s8
    s_and_b32 s49, s9, 0xffff
    s_mov_b32 s50, 0x800000
    s_mov_b32 s51, 0x20000
    v_and_b32 v1, 63, v0
    s_and_b32 s26, s3, 1
    s_lshl_b32 s26, s26, 3
    s_lshr_b32 s27, s3, 1
    v_lshrrev_b32 v3, 3, v1
    v_add_u32 v3, s26, v3
    v_lshrrev_b32 v4, 1, v3
    v_and_b32 v5, 7, v1
    v_xor_b32 v4, v4, v5
    v_lshlrev_b32 v4, 4, v4
    v_lshrrev_b32 v5, 2, v3
    v_lshlrev_b32 v5, 3, v5
    v_and_b32 v6, 3, v3
    v_add_u32 v5, v5, v6
    s_lshl_b32 s27, s27, 2
    v_add_u32 v5, s27, v5
    v_lshlrev_b32 v5, 4, v5
    v_add_u32 v5, s24, v5
    v_lshl_add_u32 v2, v5, 10, v4
    v_lshrrev_b32 v3, 4, v1
    s_lshr_b32 s26, s3, 1
    s_lshl_b32 s26, s26, 2
    v_or_b32 v4, s26, v3
    v_lshlrev_b32 v4, 1, v4
    v_and_b32 v5, 15, v1
    v_xor_b32 v4, v4, v5
    v_lshlrev_b32 v4, 4, v4
    s_lshl_b32 s26, s3, 2
    v_add_u32 v6, s26, v3
    v_mul_u32_u24 v7, 1024, v6
    v_add_u32 v7, v7, v4
    s_lshl_b32 s26, s25, 8
    v_add_u32 v7, s26, v7
    v_xor_b32 v4, v5, v6
    v_lshlrev_b32 v4, 4, v4
    v_lshl_add_u32 v8, v6, 16, v4
    s_lshl_b32 s28, s3, 10
    s_mul_i32 s72, s24, 1
    s_mul_i32 s73, s30, 2
    s_add_u32 s72, s72, s73
    s_and_b32 s72, s72, 0
    s_add_u32 s73, s72, 0
    s_and_b32 s73, s73, 7
    s_lshl_b32 s74, s73, 7
    s_mul_i32 s75, s73, 65536
    s_add_u32 m0, s28, 0
    s_add_u32 s29, s74, 0
    buffer_load_dwordx4 v2, s[32:35], s29 offen lds
    s_add_u32 m0, s28, 4096
    s_add_u32 s29, s74, 524288
    buffer_load_dwordx4 v2, s[32:35], s29 offen lds
    s_add_u32 m0, s28, 8192
    s_add_u32 s29, s74, 1048576
    buffer_load_dwordx4 v2, s[32:35], s29 offen lds
    s_add_u32 m0, s28, 12288
    s_add_u32 s29, s74, 1572864
    buffer_load_dwordx4 v2, s[32:35], s29 offen lds
    s_add_u32 m0, s28, 16384
    s_add_u32 s29, s75, 0
    buffer_load_dwordx4 v7, s[36:39], s29 offen lds
    s_add_u32 m0, s28, 20480
    s_add_u32 s29, s75, 16384
    buffer_load_dwordx4 v7, s[36:39], s29 offen lds
    s_add_u32 m0, s28, 24576
    s_add_u32 s29, s75, 0
    buffer_load_dwordx4 v7, s[40:43], s29 offen lds
    s_add_u32 m0, s28, 28672
    s_add_u32 s29, s75, 16384
    buffer_load_dwordx4 v7, s[40:43], s29 offen lds
    s_add_u32 m0, s28, 32768
    s_add_u32 s29, s75, 32768
    buffer_load_dwordx4 v7, s[36:39], s29 offen lds
    s_add_u32 m0, s28, 36864
    s_add_u32 s29, s75, 49152
    buffer_load_dwordx4 v7, s[36:39], s29 offen lds
    s_add_u32 m0, s28, 40960
    s_add_u32 s29, s75, 32768
    buffer_load_dwordx4 v7, s[40:43], s29 offen lds
    s_add_u32 m0, s28, 45056
    s_add_u32 s29, s75, 49152
    buffer_load_dwordx4 v7, s[40:43], s29 offen lds
    s_add_u32 s73, s72, 1
    s_and_b32 s73, s73, 7
    s_lshl_b32 s74, s73, 7
    s_mul_i32 s75, s73, 65536
    s_add_u32 m0, s28, 49152
    s_add_u32 s29, s74, 0
    buffer_load_dwordx4 v2, s[32:35], s29 offen lds
    s_add_u32 m0, s28, 53248
    s_add_u32 s29, s74, 524288
    buffer_load_dwordx4 v2, s[32:35], s29 offen lds
    s_add_u32 m0, s28, 57344
    s_add_u32 s29, s74, 1048576
    buffer_load_dwordx4 v2, s[32:35], s29 offen lds
    s_add_u32 m0, s28, 61440
    s_add_u32 s29, s74, 1572864
    buffer_load_dwordx4 v2, s[32:35], s29 offen lds
    s_add_u32 m0, s28, 65536
    s_add_u32 s29, s75, 0
    buffer_load_dwordx4 v7, s[36:39], s29 offen lds
    s_add_u32 m0, s28, 69632
    s_add_u32 s29, s75, 16384
    buffer_load_dwordx4 v7, s[36:39], s29 offen lds
    s_add_u32 m0, s28, 73728
    s_add_u32 s29, s75, 0
    buffer_load_dwordx4 v7, s[40:43], s29 offen lds
    s_add_u32 m0, s28, 77824
    s_add_u32 s29, s75, 16384
    buffer_load_dwordx4 v7, s[40:43], s29 offen lds
    s_mov_b32 s68, s14
    s_and_b32 s69, s15, 0xffff
    s_mov_b32 s70, 0x1c0000
    s_mov_b32 s71, 0x20000
    v_lshrrev_b32 v5, 3, v1
    v_and_b32 v6, 6, v5
    v_and_b32 v3, 7, v1
    v_xor_b32 v6, v6, v3
    v_lshlrev_b32 v6, 4, v6
    s_lshl_b32 s26, s3, 3
    v_add_u32 v5, s26, v5
    v_lshl_add_u32 v11, v5, 10, v6
    s_lshl_b32 s26, s76, 7
    v_add_u32 v11, s26, v11
    v_lshlrev_b32 v48, 4, v1
    v_add_u32 v48, s28, v48
    v_add_u32 v49, 0x10000, v48
    v_add_u32 v50, 0x20000, v48
    s_mov_b32 s64, s66
    s_and_b32 s65, s67, 0xffff
    s_mov_b32 s66, 0x100
    s_mov_b32 s67, 0x20000
    v_mov_b32 v44, 0
    s_waitcnt vmcnt(12)
    s_barrier
    s_add_u32 m0, s28, 81920
    s_add_u32 s29, s75, 32768
    buffer_load_dwordx4 v7, s[36:39], s29 offen lds
    s_add_u32 m0, s28, 86016
    s_add_u32 s29, s75, 49152
    buffer_load_dwordx4 v7, s[36:39], s29 offen lds
    s_add_u32 m0, s28, 90112
    s_add_u32 s29, s75, 32768
    buffer_load_dwordx4 v7, s[40:43], s29 offen lds
    s_add_u32 m0, s28, 94208
    s_add_u32 s29, s75, 49152
    buffer_load_dwordx4 v7, s[40:43], s29 offen lds
    s_add_u32 s73, s72, 2
    s_and_b32 s73, s73, 7
    s_lshl_b32 s74, s73, 7
    s_mul_i32 s75, s73, 65536
    s_add_u32 m0, s28, 98304
    s_add_u32 s29, s74, 0
    buffer_load_dwordx4 v2, s[32:35], s29 offen lds
    s_add_u32 m0, s28, 102400
    s_add_u32 s29, s74, 524288
    buffer_load_dwordx4 v2, s[32:35], s29 offen lds
    s_add_u32 m0, s28, 106496
    s_add_u32 s29, s74, 1048576
    buffer_load_dwordx4 v2, s[32:35], s29 offen lds
    s_add_u32 m0, s28, 110592
    s_add_u32 s29, s74, 1572864
    buffer_load_dwordx4 v2, s[32:35], s29 offen lds
    s_add_u32 m0, s28, 114688
    s_add_u32 s29, s75, 0
    buffer_load_dwordx4 v7, s[36:39], s29 offen lds
    s_add_u32 m0, s28, 118784
    s_add_u32 s29, s75, 16384
    buffer_load_dwordx4 v7, s[36:39], s29 offen lds
    s_add_u32 m0, s28, 122880
    s_add_u32 s29, s75, 0
    buffer_load_dwordx4 v7, s[40:43], s29 offen lds
    s_add_u32 m0, s28, 126976
    s_add_u32 s29, s75, 16384
    buffer_load_dwordx4 v7, s[40:43], s29 offen lds
    s_or_b32 s26, s2, s3
    s_cbranch_scc1 nn_skip
    s_memrealtime s[60:61]
    s_waitcnt lgkmcnt(0)
    v_mov_b32 v40, s60
    v_mov_b32 v41, s61
    s_mov_b64 exec, 1
    buffer_store_dwordx2 v[40:41], v44, s[64:67], 0 offen sc0 sc1
    s_mov_b64 exec, -1
    s_waitcnt vmcnt(0)
nn_skip:
    s_waitcnt vmcnt(20)
    s_barrier
    s_add_u32 m0, s28, 131072
    s_add_u32 s29, s75, 32768
    buffer_load_dwordx4 v7, s[36:39], s29 offen lds
    s_add_u32 m0, s28, 135168
    s_add_u32 s29, s75, 49152
    buffer_load_dwordx4 v7, s[36:39], s29 offen lds
    s_add_u32 m0, s28, 139264
    s_add_u32 s29, s75, 32768
    buffer_load_dwordx4 v7, s[40:43], s29 offen lds
    s_add_u32 m0, s28, 143360
    s_add_u32 s29, s75, 49152
    buffer_load_dwordx4 v7, s[40:43], s29 offen lds
    s_add_u32 s73, s72, 3
    s_and_b32 s73, s73, 7
    s_lshl_b32 s74, s73, 7
    s_mul_i32 s75, s73, 65536
    s_add_u32 m0, s28, 147456
    s_add_u32 s29, s74, 0
    buffer_load_dwordx4 v2, s[32:35], s29 offen lds
    s_add_u32 m0, s28, 151552
    s_add_u32 s29, s74, 524288
    buffer_load_dwordx4 v2, s[32:35], s29 offen lds
    s_add_u32 m0, s28, 155648
    s_add_u32 s29, s74, 1048576
    buffer_load_dwordx4 v2, s[32:35], s29 offen lds
    s_add_u32 m0, s28, 159744
    s_add_u32 s29, s74, 1572864
    buffer_load_dwordx4 v2, s[32:35], s29 offen lds
    s_add_u32 m0, s28, 16384
    s_add_u32 s29, s75, 0
    buffer_load_dwordx4 v7, s[36:39], s29 offen lds
    s_add_u32 m0, s28, 20480
    s_add_u32 s29, s75, 16384
    buffer_load_dwordx4 v7, s[36:39], s29 offen lds
    s_add_u32 m0, s28, 24576
    s_add_u32 s29, s75, 0
    buffer_load_dwordx4 v7, s[40:43], s29 offen lds
    s_add_u32 m0, s28, 28672
    s_add_u32 s29, s75, 16384
    buffer_load_dwordx4 v7, s[40:43], s29 offen lds
    s_waitcnt vmcnt(24)
    s_barrier
    s_add_u32 m0, s28, 32768
    s_add_u32 s29, s75, 32768
    buffer_load_dwordx4 v7, s[36:39], s29 offen lds
    s_add_u32 m0, s28, 36864
    s_add_u32 s29, s75, 49152
    buffer_load_dwordx4 v7, s[36:39], s29 offen lds
    s_add_u32 m0, s28, 40960
    s_add_u32 s29, s75, 32768
    buffer_load_dwordx4 v7, s[40:43], s29 offen lds
    s_add_u32 m0, s28, 45056
    s_add_u32 s29, s75, 49152
    buffer_load_dwordx4 v7, s[40:43], s29 offen lds
    s_add_u32 s73, s72, 4
    s_and_b32 s73, s73, 7
    s_lshl_b32 s74, s73, 7
    s_mul_i32 s75, s73, 65536
    s_add_u32 m0, s28, 0
    s_add_u32 s29, s74, 0
    buffer_load_dwordx4 v2, s[32:35], s29 offen lds
    s_add_u32 m0, s28, 4096
    s_add_u32 s29, s74, 524288
    buffer_load_dwordx4 v2, s[32:35], s29 offen lds
    s_add_u32 m0, s28, 8192
    s_add_u32 s29, s74, 1048576
    buffer_load_dwordx4 v2, s[32:35], s29 offen lds
    s_add_u32 m0, s28, 12288
    s_add_u32 s29, s74, 1572864
    buffer_load_dwordx4 v2, s[32:35], s29 offen lds
    s_waitcnt vmcnt(28)
    s_barrier
    s_add_u32 m0, s28, 65536
    s_add_u32 s29, s75, 0
    buffer_load_dwordx4 v7, s[36:39], s29 offen lds
    s_add_u32 m0, s28, 69632
    s_add_u32 s29, s75, 16384
    buffer_load_dwordx4 v7, s[36:39], s29 offen lds
    s_add_u32 m0, s28, 73728
    s_add_u32 s29, s75, 0
    buffer_load_dwordx4 v7, s[40:43], s29 offen lds
    s_add_u32 m0, s28, 77824
    s_add_u32 s29, s75, 16384
    buffer_load_dwordx4 v7, s[40:43], s29 offen lds
    s_waitcnt vmcnt(24)
    s_barrier
    s_add_u32 m0, s28, 81920
    s_add_u32 s29, s75, 32768
    buffer_load_dwordx4 v7, s[36:39], s29 offen lds
    s_add_u32 m0, s28, 86016
    s_add_u32 s29, s75, 49152
    buffer_load_dwordx4 v7, s[36:39], s29 offen lds
    s_add_u32 m0, s28, 90112
    s_add_u32 s29, s75, 32768
    buffer_load_dwordx4 v7, s[40:43], s29 offen lds
    s_add_u32 m0, s28, 94208
    s_add_u32 s29, s75, 49152
    buffer_load_dwordx4 v7, s[40:43], s29 offen lds
    s_add_u32 s73, s72, 5
    s_and_b32 s73, s73, 7
    s_lshl_b32 s74, s73, 7
    s_mul_i32 s75, s73, 65536
    s_add_u32 m0, s28, 49152
    s_add_u32 s29, s74, 0
    buffer_load_dwordx4 v2, s[32:35], s29 offen lds
    s_add_u32 m0, s28, 53248
    s_add_u32 s29, s74, 524288
    buffer_load_dwordx4 v2, s[32:35], s29 offen lds
    s_add_u32 m0, s28, 57344
    s_add_u32 s29, s74, 1048576
    buffer_load_dwordx4 v2, s[32:35], s29 offen lds
    s_add_u32 m0, s28, 61440
    s_add_u32 s29, s74, 1572864
    buffer_load_dwordx4 v2, s[32:35], s29 offen lds
    s_waitcnt vmcnt(28)
    s_barrier
    s_add_u32 m0, s28, 114688
    s_add_u32 s29, s75, 0
    buffer_load_dwordx4 v7, s[36:39], s29 offen lds
    s_add_u32 m0, s28, 118784
    s_add_u32 s29, s75, 16384
    buffer_load_dwordx4 v7, s[36:39], s29 offen lds
    s_add_u32 m0, s28, 122880
    s_add_u32 s29, s75, 0
    buffer_load_dwordx4 v7, s[40:43], s29 offen lds
    s_add_u32 m0, s28, 126976
    s_add_u32 s29, s75, 16384
    buffer_load_dwordx4 v7, s[40:43], s29 offen lds
    s_waitcnt vmcnt(24)
    s_barrier
    s_add_u32 m0, s28, 131072
    s_add_u32 s29, s75, 32768
    buffer_load_dwordx4 v7, s[36:39], s29 offen lds
    s_add_u32 m0, s28, 135168
    s_add_u32 s29, s75, 49152
    buffer_load_dwordx4 v7, s[36:39], s29 offen lds
    s_add_u32 m0, s28, 139264
    s_add_u32 s29, s75, 32768
    buffer_load_dwordx4 v7, s[40:43], s29 offen lds
    s_add_u32 m0, s28, 143360
    s_add_u32 s29, s75, 49152
    buffer_load_dwordx4 v7, s[40:43], s29 offen lds
    s_add_u32 s73, s72, 6
    s_and_b32 s73, s73, 7
    s_lshl_b32 s74, s73, 7
    s_mul_i32 s75, s73, 65536
    s_add_u32 m0, s28, 98304
    s_add_u32 s29, s74, 0
    buffer_load_dwordx4 v2, s[32:35], s29 offen lds
    s_add_u32 m0, s28, 102400
    s_add_u32 s29, s74, 524288
    buffer_load_dwordx4 v2, s[32:35], s29 offen lds
    s_add_u32 m0, s28, 106496
    s_add_u32 s29, s74, 1048576
    buffer_load_dwordx4 v2, s[32:35], s29 offen lds
    s_add_u32 m0, s28, 110592
    s_add_u32 s29, s74, 1572864
    buffer_load_dwordx4 v2, s[32:35], s29 offen lds
    s_waitcnt vmcnt(28)
    s_barrier
    s_add_u32 m0, s28, 16384
    s_add_u32 s29, s75, 0
    buffer_load_dwordx4 v7, s[36:39], s29 offen lds
    s_add_u32 m0, s28, 20480
    s_add_u32 s29, s75, 16384
    buffer_load_dwordx4 v7, s[36:39], s29 offen lds
    s_add_u32 m0, s28, 24576
    s_add_u32 s29, s75, 0
    buffer_load_dwordx4 v7, s[40:43], s29 offen lds
    s_add_u32 m0, s28, 28672
    s_add_u32 s29, s75, 16384
    buffer_load_dwordx4 v7, s[40:43], s29 offen lds
    s_waitcnt vmcnt(24)
    s_barrier
    s_add_u32 m0, s28, 32768
    s_add_u32 s29, s75, 32768
    buffer_load_dwordx4 v7, s[36:39], s29 offen lds
    s_add_u32 m0, s28, 36864
    s_add_u32 s29, s75, 49152
    buffer_load_dwordx4 v7, s[36:39], s29 offen lds
    s_add_u32 m0, s28, 40960
    s_add_u32 s29, s75, 32768
    buffer_load_dwordx4 v7, s[40:43], s29 offen lds
    s_add_u32 m0, s28, 45056
    s_add_u32 s29, s75, 49152
    buffer_load_dwordx4 v7, s[40:43], s29 offen lds
    s_add_u32 s73, s72, 7
    s_and_b32 s73, s73, 7
    s_lshl_b32 s74, s73, 7
    s_mul_i32 s75, s73, 65536
    s_add_u32 m0, s28, 147456
    s_add_u32 s29, s74, 0
    buffer_load_dwordx4 v2, s[32:35], s29 offen lds
    s_add_u32 m0, s28, 151552
    s_add_u32 s29, s74, 524288
    buffer_load_dwordx4 v2, s[32:35], s29 offen lds
    s_add_u32 m0, s28, 155648
    s_add_u32 s29, s74, 1048576
    buffer_load_dwordx4 v2, s[32:35], s29 offen lds
    s_add_u32 m0, s28, 159744
    s_add_u32 s29, s74, 1572864
    buffer_load_dwordx4 v2, s[32:35], s29 offen lds
    s_waitcnt vmcnt(28)
    s_barrier
    s_add_u32 m0, s28, 65536
    s_add_u32 s29, s75, 0
    buffer_load_dwordx4 v7, s[36:39], s29 offen lds
    s_add_u32 m0, s28, 69632
    s_add_u32 s29, s75, 16384
    buffer_load_dwordx4 v7, s[36:39], s29 offen lds
    s_add_u32 m0, s28, 73728
    s_add_u32 s29, s75, 0
    buffer_load_dwordx4 v7, s[40:43], s29 offen lds
    s_add_u32 m0, s28, 77824
    s_add_u32 s29, s75, 16384
    buffer_load_dwordx4 v7, s[40:43], s29 offen lds
    s_waitcnt vmcnt(24)
    s_barrier
    s_add_u32 m0, s28, 81920
    s_add_u32 s29, s75, 32768
    buffer_load_dwordx4 v7, s[36:39], s29 offen lds
    s_add_u32 m0, s28, 86016
    s_add_u32 s29, s75, 49152
    buffer_load_dwordx4 v7, s[36:39], s29 offen lds
    s_add_u32 m0, s28, 90112
    s_add_u32 s29, s75, 32768
    buffer_load_dwordx4 v7, s[40:43], s29 offen lds
    s_add_u32 m0, s28, 94208
    s_add_u32 s29, s75, 49152
    buffer_load_dwordx4 v7, s[40:43], s29 offen lds
    s_add_u32 m0, s28, 0
    s_mov_b32 s29, 0
    buffer_load_dwordx4 v8, s[44:47], s29 offen lds
    s_add_u32 m0, s28, 4096
    s_mov_b32 s29, 1048576
    buffer_load_dwordx4 v8, s[44:47], s29 offen lds
    s_add_u32 m0, s28, 8192
    s_mov_b32 s29, 2097152
    buffer_load_dwordx4 v8, s[44:47], s29 offen lds
    s_add_u32 m0, s28, 12288
    s_mov_b32 s29, 3145728
    buffer_load_dwordx4 v8, s[44:47], s29 offen lds
    s_waitcnt vmcnt(28)
    s_barrier
    s_add_u32 m0, s28, 114688
    s_mov_b32 s29, 0
    buffer_load_dwordx4 v8, s[48:51], s29 offen lds
    s_add_u32 m0, s28, 118784
    s_mov_b32 s29, 1048576
    buffer_load_dwordx4 v8, s[48:51], s29 offen lds
    s_add_u32 m0, s28, 122880
    s_mov_b32 s29, 2097152
    buffer_load_dwordx4 v8, s[48:51], s29 offen lds
    s_add_u32 m0, s28, 126976
    s_mov_b32 s29, 3145728
    buffer_load_dwordx4 v8, s[48:51], s29 offen lds
    s_waitcnt vmcnt(24)
    s_barrier
    s_add_u32 s62, s101, 0
    s_sub_u32 s63, s62, 14
    s_cselect_b32 s62, s62, s63
    s_lshl_b32 s62, s62, 17
    s_add_u32 m0, s28, 131072
    s_add_u32 s29, s62, 0
    buffer_load_dwordx4 v11, s[68:71], s29 offen lds
    s_add_u32 m0, s28, 135168
    s_add_u32 s29, s62, 32768
    buffer_load_dwordx4 v11, s[68:71], s29 offen lds
    s_add_u32 m0, s28, 139264
    s_add_u32 s29, s62, 65536
    buffer_load_dwordx4 v11, s[68:71], s29 offen lds
    s_add_u32 m0, s28, 143360
    s_add_u32 s29, s62, 98304
    buffer_load_dwordx4 v11, s[68:71], s29 offen lds
    s_add_u32 s62, s101, 1
    s_sub_u32 s63, s62, 14
    s_cselect_b32 s62, s62, s63
    s_lshl_b32 s62, s62, 17
    s_add_u32 m0, s28, 49152
    s_add_u32 s29, s62, 0
    buffer_load_dwordx4 v11, s[68:71], s29 offen lds
    s_add_u32 m0, s28, 53248
    s_add_u32 s29, s62, 32768
    buffer_load_dwordx4 v11, s[68:71], s29 offen lds
    s_add_u32 m0, s28, 57344
    s_add_u32 s29, s62, 65536
    buffer_load_dwordx4 v11, s[68:71], s29 offen lds
    s_add_u32 m0, s28, 61440
    s_add_u32 s29, s62, 98304
    buffer_load_dwordx4 v11, s[68:71], s29 offen lds
    buffer_load_dwordx2 v[40:41], v44, s[64:67], 0 offen sc0 sc1
    s_mov_b32 s52, s22
    s_and_b32 s53, s23, 0xffff
    s_mov_b32 s54, 0xa04000
    s_mov_b32 s55, 0x20000
    s_mov_b32 s56, s20
    s_and_b32 s57, s21, 0xffff
    s_mov_b32 s58, 0x400
    s_mov_b32 s59, 0x20000
    v_lshlrev_b32 v9, 4, v1
    s_lshl_b32 s26, s30, 3
    s_lshl_b32 s27, s3, 1
    s_add_u32 s26, s26, s27
    s_lshl_b32 s26, s26, 4
    s_add_u32 s31, s26, s24
    s_lshl_b32 s26, s31, 10
    s_add_u32 s27, s26, 16384
    buffer_load_dwordx4 v[12:15], v9, s[56:59], 0 offen
    buffer_load_dwordx4 v[16:19], v9, s[32:35], s26 offen
    buffer_load_dwordx4 v[20:23], v9, s[32:35], s27 offen
    s_waitcnt vmcnt(32)
    s_barrier
    s_add_u32 s62, s101, 2
    s_sub_u32 s63, s62, 14
    s_cselect_b32 s62, s62, s63
    s_lshl_b32 s62, s62, 17
    s_add_u32 m0, s28, 16384
    s_add_u32 s29, s62, 0
    buffer_load_dwordx4 v11, s[68:71], s29 offen lds
    s_add_u32 m0, s28, 20480
    s_add_u32 s29, s62, 32768
    buffer_load_dwordx4 v11, s[68:71], s29 offen lds
    s_add_u32 m0, s28, 24576
    s_add_u32 s29, s62, 65536
    buffer_load_dwordx4 v11, s[68:71], s29 offen lds
    s_add_u32 m0, s28, 28672
    s_add_u32 s29, s62, 98304
    buffer_load_dwordx4 v11, s[68:71], s29 offen lds
    s_waitcnt vmcnt(28)
    s_barrier
    s_add_u32 s62, s101, 3
    s_sub_u32 s63, s62, 14
    s_cselect_b32 s62, s62, s63
    s_lshl_b32 s62, s62, 17
    s_add_u32 m0, s28, 32768
    s_add_u32 s29, s62, 0
    buffer_load_dwordx4 v11, s[68:71], s29 offen lds
    s_add_u32 m0, s28, 36864
    s_add_u32 s29, s62, 32768
    buffer_load_dwordx4 v11, s[68:71], s29 offen lds
    s_add_u32 m0, s28, 40960
    s_add_u32 s29, s62, 65536
    buffer_load_dwordx4 v11, s[68:71], s29 offen lds
    s_add_u32 m0, s28, 45056
    s_add_u32 s29, s62, 98304
    buffer_load_dwordx4 v11, s[68:71], s29 offen lds
    s_add_u32 s62, s101, 4
    s_sub_u32 s63, s62, 14
    s_cselect_b32 s62, s62, s63
    s_lshl_b32 s62, s62, 17
    s_add_u32 m0, s28, 98304
    s_add_u32 s29, s62, 0
    buffer_load_dwordx4 v11, s[68:71], s29 offen lds
    s_add_u32 m0, s28, 102400
    s_add_u32 s29, s62, 32768
    buffer_load_dwordx4 v11, s[68:71], s29 offen lds
    s_add_u32 m0, s28, 106496
    s_add_u32 s29, s62, 65536
    buffer_load_dwordx4 v11, s[68:71], s29 offen lds
    s_add_u32 m0, s28, 110592
    s_add_u32 s29, s62, 98304
    buffer_load_dwordx4 v11, s[68:71], s29 offen lds
    s_waitcnt vmcnt(32)
    s_barrier
    s_add_u32 s62, s101, 5
    s_sub_u32 s63, s62, 14
    s_cselect_b32 s62, s62, s63
    s_lshl_b32 s62, s62, 17
    s_add_u32 m0, s28, 65536
    s_add_u32 s29, s62, 0
    buffer_load_dwordx4 v11, s[68:71], s29 offen lds
    s_add_u32 m0, s28, 69632
    s_add_u32 s29, s62, 32768
    buffer_load_dwordx4 v11, s[68:71], s29 offen lds
    s_add_u32 m0, s28, 73728
    s_add_u32 s29, s62, 65536
    buffer_load_dwordx4 v11, s[68:71], s29 offen lds
    s_add_u32 m0, s28, 77824
    s_add_u32 s29, s62, 98304
    buffer_load_dwordx4 v11, s[68:71], s29 offen lds
    s_waitcnt vmcnt(28)
    s_barrier
    s_add_u32 s62, s101, 6
    s_sub_u32 s63, s62, 14
    s_cselect_b32 s62, s62, s63
    s_lshl_b32 s62, s62, 17
    s_add_u32 m0, s28, 81920
    s_add_u32 s29, s62, 0
    buffer_load_dwordx4 v11, s[68:71], s29 offen lds
    s_add_u32 m0, s28, 86016
    s_add_u32 s29, s62, 32768
    buffer_load_dwordx4 v11, s[68:71], s29 offen lds
    s_add_u32 m0, s28, 90112
    s_add_u32 s29, s62, 65536
    buffer_load_dwordx4 v11, s[68:71], s29 offen lds
    s_add_u32 m0, s28, 94208
    s_add_u32 s29, s62, 98304
    buffer_load_dwordx4 v11, s[68:71], s29 offen lds
    s_add_u32 s62, s101, 7
    s_sub_u32 s63, s62, 14
    s_cselect_b32 s62, s62, s63
    s_lshl_b32 s62, s62, 17
    s_add_u32 m0, s28, 147456
    s_add_u32 s29, s62, 0
    buffer_load_dwordx4 v11, s[68:71], s29 offen lds
    s_add_u32 m0, s28, 151552
    s_add_u32 s29, s62, 32768
    buffer_load_dwordx4 v11, s[68:71], s29 offen lds
    s_add_u32 m0, s28, 155648
    s_add_u32 s29, s62, 65536
    buffer_load_dwordx4 v11, s[68:71], s29 offen lds
    s_add_u32 m0, s28, 159744
    s_add_u32 s29, s62, 98304
    buffer_load_dwordx4 v11, s[68:71], s29 offen lds
    s_waitcnt vmcnt(27)
    s_mov_b32 s27, 0x40000
nnd:
    v_cmp_ne_u64 vcc, 0, v[40:41]
    s_sub_u32 s27, s27, 1
    s_cbranch_scc1 nnd_d
    s_nop 3
    s_cbranch_vccnz nnd_d
    buffer_load_dwordx2 v[40:41], v44, s[64:67], 0 offen sc0 sc1
    s_waitcnt vmcnt(0)
    s_branch nnd
nnd_d:
    s_waitcnt vmcnt(24)
    v_lshlrev_b32 v24, 16, v12
    v_and_b32 v25, 0xffff0000, v12
    v_lshlrev_b32 v26, 16, v13
    v_and_b32 v27, 0xffff0000, v13
    v_lshlrev_b32 v28, 16, v14
    v_and_b32 v29, 0xffff0000, v14
    v_lshlrev_b32 v30, 16, v15
    v_and_b32 v31, 0xffff0000, v15
    v_lshlrev_b32 v32, 16, v16
    v_and_b32 v33, 0xffff0000, v16
    v_mul_f32 v32, v32, v24
    v_mul_f32 v33, v33, v25
    v_cvt_pk_bf16_f32 v32, v32, v33
    v_and_b32 v33, 0xffff0000, v32
    v_lshlrev_b32 v32, 16, v32
    v_add_f32 v34, v32, v33
    v_lshlrev_b32 v32, 16, v17
    v_and_b32 v33, 0xffff0000, v17
    v_mul_f32 v32, v32, v26
    v_mul_f32 v33, v33, v27
    v_cvt_pk_bf16_f32 v32, v32, v33
    v_and_b32 v33, 0xffff0000, v32
    v_lshlrev_b32 v32, 16, v32
    v_add_f32 v32, v32, v33
    v_add_f32 v34, v34, v32
    v_lshlrev_b32 v32, 16, v18
    v_and_b32 v33, 0xffff0000, v18
    v_mul_f32 v32, v32, v28
    v_mul_f32 v33, v33, v29
    v_cvt_pk_bf16_f32 v32, v32, v33
    v_and_b32 v33, 0xffff0000, v32
    v_lshlrev_b32 v32, 16, v32
    v_add_f32 v32, v32, v33
    v_add_f32 v34, v34, v32
    v_lshlrev_b32 v32, 16, v19
    v_and_b32 v33, 0xffff0000, v19
    v_mul_f32 v32, v32, v30
    v_mul_f32 v33, v33, v31
    v_cvt_pk_bf16_f32 v32, v32, v33
    v_and_b32 v33, 0xffff0000, v32
    v_lshlrev_b32 v32, 16, v32
    v_add_f32 v32, v32, v33
    v_add_f32 v34, v34, v32
    v_lshlrev_b32 v32, 16, v20
    v_and_b32 v33, 0xffff0000, v20
    v_mul_f32 v32, v32, v24
    v_mul_f32 v33, v33, v25
    v_cvt_pk_bf16_f32 v32, v32, v33
    v_and_b32 v33, 0xffff0000, v32
    v_lshlrev_b32 v32, 16, v32
    v_add_f32 v35, v32, v33
    v_lshlrev_b32 v32, 16, v21
    v_and_b32 v33, 0xffff0000, v21
    v_mul_f32 v32, v32, v26
    v_mul_f32 v33, v33, v27
    v_cvt_pk_bf16_f32 v32, v32, v33
    v_and_b32 v33, 0xffff0000, v32
    v_lshlrev_b32 v32, 16, v32
    v_add_f32 v32, v32, v33
    v_add_f32 v35, v35, v32
    v_lshlrev_b32 v32, 16, v22
    v_and_b32 v33, 0xffff0000, v22
    v_mul_f32 v32, v32, v28
    v_mul_f32 v33, v33, v29
    v_cvt_pk_bf16_f32 v32, v32, v33
    v_and_b32 v33, 0xffff0000, v32
    v_lshlrev_b32 v32, 16, v32
    v_add_f32 v32, v32, v33
    v_add_f32 v35, v35, v32
    v_lshlrev_b32 v32, 16, v23
    v_and_b32 v33, 0xffff0000, v23
    v_mul_f32 v32, v32, v30
    v_mul_f32 v33, v33, v31
    v_cvt_pk_bf16_f32 v32, v32, v33
    v_and_b32 v33, 0xffff0000, v32
    v_lshlrev_b32 v32, 16, v32
    v_add_f32 v32, v32, v33
    v_add_f32 v35, v35, v32
    s_nop 1
    v_add_f32_dpp v34, v34, v34 row_ror:8 row_mask:0xf bank_mask:0xf
    v_add_f32_dpp v35, v35, v35 row_ror:8 row_mask:0xf bank_mask:0xf
    s_nop 1
    v_add_f32_dpp v34, v34, v34 row_ror:4 row_mask:0xf bank_mask:0xf
    v_add_f32_dpp v35, v35, v35 row_ror:4 row_mask:0xf bank_mask:0xf
    s_nop 1
    v_add_f32_dpp v34, v34, v34 row_ror:2 row_mask:0xf bank_mask:0xf
    v_add_f32_dpp v35, v35, v35 row_ror:2 row_mask:0xf bank_mask:0xf
    s_nop 1
    v_add_f32_dpp v34, v34, v34 row_ror:1 row_mask:0xf bank_mask:0xf
    v_add_f32_dpp v35, v35, v35 row_ror:1 row_mask:0xf bank_mask:0xf
    s_nop 1
    v_readlane_b32 s60, v34, 16
    v_readlane_b32 s61, v34, 32
    v_readlane_b32 s62, v34, 48
    v_readlane_b32 s63, v35, 16
    v_readlane_b32 s64, v35, 32
    v_readlane_b32 s65, v35, 48
    s_nop 1
    v_add_f32 v34, s60, v34
    v_add_f32 v34, s61, v34
    v_add_f32 v34, s62, v34
    v_add_f32 v35, s63, v35
    v_add_f32 v35, s64, v35
    v_add_f32 v35, s65, v35
    v_cvt_pk_bf16_f32 v34, v34, v35
    v_and_b32 v35, 0xffff0000, v34
    v_lshlrev_b32 v34, 16, v34
    v_mul_f32 v34, 0xbfb8aa3b, v34
    v_mul_f32 v35, 0xbfb8aa3b, v35
    v_exp_f32 v34, v34
    v_exp_f32 v35, v35
    s_nop 0
    v_add_f32 v34, 1.0, v34
    v_add_f32 v35, 1.0, v35
    v_rcp_f32 v34, v34
    v_rcp_f32 v35, v35
    s_nop 0
    v_cvt_pk_bf16_f32 v34, v34, v35
    v_and_b32 v35, 0xffff0000, v34
    v_lshlrev_b32 v34, 16, v34
    s_lshl_b32 s26, s31, 2
    s_add_u32 s26, s26, 10485760
    v_mov_b32 v36, 0
    s_mov_b64 exec, 1
    buffer_store_dword v34, v36, s[52:55], s26 offen sc1
    buffer_store_dword v35, v36, s[52:55], s26 offen offset:64 sc1
    s_mov_b64 exec, -1
    v_lshlrev_b32 v44, 9, v1
    s_lshl_b32 s26, s24, 1
    s_add_u32 s26, s26, s25
    s_lshl_b32 s26, s26, 3
    s_add_u32 s26, s26, 10494080
    s_waitcnt vmcnt(0)
    s_barrier
    s_cmp_lg_u32 s3, 0
    s_cbranch_scc1 nosigd
    s_mov_b64 exec, 65535
    buffer_store_dwordx2 v[40:41], v44, s[52:55], s26 offen sc0 sc1
    s_mov_b64 exec, -1
nosigd:
    s_add_u32 s62, s101, 8
    s_sub_u32 s63, s62, 14
    s_cselect_b32 s62, s62, s63
    s_lshl_b32 s62, s62, 17
    s_add_u32 m0, s28, 0
    s_add_u32 s29, s62, 0
    buffer_load_dwordx4 v11, s[68:71], s29 offen lds
    s_add_u32 m0, s28, 4096
    s_add_u32 s29, s62, 32768
    buffer_load_dwordx4 v11, s[68:71], s29 offen lds
    s_add_u32 m0, s28, 8192
    s_add_u32 s29, s62, 65536
    buffer_load_dwordx4 v11, s[68:71], s29 offen lds
    s_add_u32 m0, s28, 12288
    s_add_u32 s29, s62, 98304
    buffer_load_dwordx4 v11, s[68:71], s29 offen lds
ld2:
    s_add_u32 s62, s101, 9
    s_sub_u32 s63, s62, 14
    s_cselect_b32 s62, s62, s63
    s_lshl_b32 s62, s62, 17
    s_add_u32 s29, s62, 0
    buffer_load_dwordx4 v[64:67], v11, s[68:71], s29 offen
    s_add_u32 s29, s62, 32768
    buffer_load_dwordx4 v[68:71], v11, s[68:71], s29 offen
    s_add_u32 s29, s62, 65536
    buffer_load_dwordx4 v[72:75], v11, s[68:71], s29 offen
    s_add_u32 s29, s62, 98304
    buffer_load_dwordx4 v[76:79], v11, s[68:71], s29 offen
    s_add_u32 s62, s101, 10
    s_sub_u32 s63, s62, 14
    s_cselect_b32 s62, s62, s63
    s_lshl_b32 s62, s62, 17
    s_add_u32 s29, s62, 0
    buffer_load_dwordx4 v[80:83], v11, s[68:71], s29 offen
    s_add_u32 s29, s62, 32768
    buffer_load_dwordx4 v[84:87], v11, s[68:71], s29 offen
    s_add_u32 s29, s62, 65536
    buffer_load_dwordx4 v[88:91], v11, s[68:71], s29 offen
    s_add_u32 s29, s62, 98304
    buffer_load_dwordx4 v[92:95], v11, s[68:71], s29 offen
    s_add_u32 s62, s101, 11
    s_sub_u32 s63, s62, 14
    s_cselect_b32 s62, s62, s63
    s_lshl_b32 s62, s62, 17
    s_add_u32 s29, s62, 0
    buffer_load_dwordx4 v[96:99], v11, s[68:71], s29 offen
    s_add_u32 s29, s62, 32768
    buffer_load_dwordx4 v[100:103], v11, s[68:71], s29 offen
    s_add_u32 s29, s62, 65536
    buffer_load_dwordx4 v[104:107], v11, s[68:71], s29 offen
    s_add_u32 s29, s62, 98304
    buffer_load_dwordx4 v[108:111], v11, s[68:71], s29 offen
    s_add_u32 s62, s101, 12
    s_sub_u32 s63, s62, 14
    s_cselect_b32 s62, s62, s63
    s_lshl_b32 s62, s62, 17
    s_add_u32 s29, s62, 0
    buffer_load_dwordx4 v[112:115], v11, s[68:71], s29 offen
    s_add_u32 s29, s62, 32768
    buffer_load_dwordx4 v[116:119], v11, s[68:71], s29 offen
    s_add_u32 s29, s62, 65536
    buffer_load_dwordx4 v[120:123], v11, s[68:71], s29 offen
    s_add_u32 s29, s62, 98304
    buffer_load_dwordx4 v[124:127], v11, s[68:71], s29 offen
    s_add_u32 s62, s101, 13
    s_sub_u32 s63, s62, 14
    s_cselect_b32 s62, s62, s63
    s_lshl_b32 s62, s62, 17
    s_add_u32 s29, s62, 0
    buffer_load_dwordx4 v[128:131], v11, s[68:71], s29 offen
    s_add_u32 s29, s62, 32768
    buffer_load_dwordx4 v[132:135], v11, s[68:71], s29 offen
    s_add_u32 s29, s62, 65536
    buffer_load_dwordx4 v[136:139], v11, s[68:71], s29 offen
    s_add_u32 s29, s62, 98304
    buffer_load_dwordx4 v[140:143], v11, s[68:71], s29 offen
    s_mov_b32 s24, s98
    s_mov_b32 s25, s76
    v_lshlrev_b32 v45, 3, v1
    v_mbcnt_lo_u32_b32 v1, -1, 0
    v_mbcnt_hi_u32_b32 v1, -1, v1
    v_and_b32 v2, 15, v1
    v_lshrrev_b32 v3, 4, v1
    s_and_b32 s26, s3, 1
    s_lshl_b32 s26, s26, 1
    s_lshr_b32 s27, s3, 1
    s_mul_i32 s28, s26, 16
    s_add_u32 s28, s28, s24
    s_mul_i32 s23, s27, 16
    s_add_u32 s23, s23, s28
    s_lshl_b32 s26, s3, 12
    s_add_u32 s26, s26, 65536
    v_lshlrev_b32 v52, 4, v1
    v_add_u32 v52, s26, v52
    s_lshl_b32 s26, s3, 8
    s_add_u32 s26, s26, 81920
    v_lshlrev_b32 v53, 2, v1
    v_add_u32 v53, s26, v53
    s_sub_u32 s26, 128, s23
    s_and_b32 s26, s26, 63
    s_cmp_gt_u32 s23, 63
    s_cselect_b32 s31, s26, s23
    s_cselect_b32 s60, 0x8000, 0
    s_cmp_gt_u32 s25, 3
    s_cselect_b32 s61, 0x8000, 0
    s_cselect_b32 s62, -16, 16
    s_lshl_b32 s26, s25, 6
    v_add_u32 v7, s26, v2
    v_add_u32 v8, 0, v7
    v_mul_lo_u32 v8, s62, v8
    v_and_b32 v8, 0xff0, v8
    v_lshl_add_u32 v252, v3, 13, v8
    v_add_u32 v8, 16, v7
    v_mul_lo_u32 v8, s62, v8
    v_and_b32 v8, 0xff0, v8
    v_lshl_add_u32 v253, v3, 13, v8
    v_add_u32 v8, 32, v7
    v_mul_lo_u32 v8, s62, v8
    v_and_b32 v8, 0xff0, v8
    v_lshl_add_u32 v254, v3, 13, v8
    v_add_u32 v8, 48, v7
    v_mul_lo_u32 v8, s62, v8
    v_and_b32 v8, 0xff0, v8
    v_lshl_add_u32 v255, v3, 13, v8
    s_lshr_b32 s26, s31, 1
    s_lshl_b32 s26, s26, 16
    s_and_b32 s63, s31, 1
    s_lshl_b32 s63, s63, 3
    s_add_u32 s26, s26, s63
    s_add_u32 s64, s26, 8388608
    s_add_u32 s65, s64, 4096
    s_add_u32 s66, s64, 32768
    s_add_u32 s67, s64, 36864
    v_lshlrev_b32 v8, 7, v2
    v_add_u32 v8, s23, v8
    v_lshlrev_b32 v246, 2, v8
    v_cmp_eq_u32 s[68:69], 0, v2
    s_and_b32 s26, s25, 3
    s_cmp_eq_u32 s26, 0
    s_cselect_b64 s[68:69], s[68:69], 0
    s_cmp_eq_u32 s25, 4
    s_cselect_b64 s[70:71], s[68:69], 0
    v_lshlrev_b32 v16, 1, v3
    v_mul_u32_u24 v16, v16, v8
    v_mad_u32_u24 v17, v8, 0, v16
    v_and_b32 v17, 0x7ff, v17
    v_cvt_f32_u32 v17, v17
    v_mul_f32 v17, 0x3a000000, v17
    v_cos_f32 v18, v17
    v_sin_f32 v20, -v17
    v_mad_u32_u24 v17, v8, 1, v16
    v_and_b32 v17, 0x7ff, v17
    v_cvt_f32_u32 v17, v17
    v_mul_f32 v17, 0x3a000000, v17
    v_cos_f32 v19, v17
    v_sin_f32 v21, -v17
    s_nop 0
    v_cvt_pk_bf16_f32 v248, v18, v19
    v_cvt_pk_bf16_f32 v250, v20, v21
    v_mad_u32_u24 v17, v8, 8, v16
    v_and_b32 v17, 0x7ff, v17
    v_cvt_f32_u32 v17, v17
    v_mul_f32 v17, 0x3a000000, v17
    v_cos_f32 v18, v17
    v_sin_f32 v20, -v17
    v_mad_u32_u24 v17, v8, 9, v16
    v_and_b32 v17, 0x7ff, v17
    v_cvt_f32_u32 v17, v17
    v_mul_f32 v17, 0x3a000000, v17
    v_cos_f32 v19, v17
    v_sin_f32 v21, -v17
    s_nop 0
    v_cvt_pk_bf16_f32 v249, v18, v19
    v_cvt_pk_bf16_f32 v251, v20, v21
    s_xor_b32 s72, s60, 0x8000
    s_lshl_b32 s72, s72, 16
    s_xor_b32 s73, s61, 0x8000
    s_xor_b32 s26, s73, s60
    s_lshl_b32 s26, s26, 16
    s_or_b32 s73, s73, s26
    s_cmp_eq_u32 s31, 0
    s_cselect_b32 s74, 0xffff, -1
    s_cmp_eq_u32 s23, 64
    s_cselect_b32 s75, 16, 0
    s_mov_b32 s76, 0x05040100
    s_mov_b32 s77, 0x07060302
    v_perm_b32 v224, v250, v248, s76
    v_perm_b32 v225, v248, v250, s76
    v_xor_b32 v224, s72, v224
    v_xor_b32 v225, s73, v225
    v_and_b32 v224, s74, v224
    v_lshlrev_b32 v224, s75, v224
    v_and_b32 v225, s74, v225
    v_lshlrev_b32 v225, s75, v225
    v_perm_b32 v226, v250, v248, s77
    v_perm_b32 v227, v248, v250, s77
    v_xor_b32 v226, s72, v226
    v_xor_b32 v227, s73, v227
    v_and_b32 v226, s74, v226
    v_lshlrev_b32 v226, s75, v226
    v_and_b32 v227, s74, v227
    v_lshlrev_b32 v227, s75, v227
    v_perm_b32 v228, v251, v249, s76
    v_perm_b32 v229, v249, v251, s76
    v_xor_b32 v228, s72, v228
    v_xor_b32 v229, s73, v229
    v_and_b32 v228, s74, v228
    v_lshlrev_b32 v228, s75, v228
    v_and_b32 v229, s74, v229
    v_lshlrev_b32 v229, s75, v229
    v_perm_b32 v230, v251, v249, s77
    v_perm_b32 v231, v249, v251, s77
    v_xor_b32 v230, s72, v230
    v_xor_b32 v231, s73, v231
    v_and_b32 v230, s74, v230
    v_lshlrev_b32 v230, s75, v230
    v_and_b32 v231, s74, v231
    v_lshlrev_b32 v231, s75, v231
    s_waitcnt vmcnt(0)
    s_waitcnt lgkmcnt(0)
    s_barrier
    ds_write_b128 v50, v[64:67] offset:0
    ds_write_b128 v50, v[68:71] offset:4096
    ds_write_b128 v50, v[72:75] offset:8192
    ds_write_b128 v50, v[76:79] offset:12288
    ds_write_b128 v48, v[80:83] offset:49152
    ds_write_b128 v48, v[84:87] offset:53248
    ds_write_b128 v48, v[88:91] offset:57344
    ds_write_b128 v48, v[92:95] offset:61440
    ds_write_b128 v48, v[96:99] offset:16384
    ds_write_b128 v48, v[100:103] offset:20480
    ds_write_b128 v48, v[104:107] offset:24576
    ds_write_b128 v48, v[108:111] offset:28672
    ds_write_b128 v48, v[112:115] offset:32768
    ds_write_b128 v48, v[116:119] offset:36864
    ds_write_b128 v48, v[120:123] offset:40960
    ds_write_b128 v48, v[124:127] offset:45056
    ds_write_b128 v49, v[128:131] offset:32768
    ds_write_b128 v49, v[132:135] offset:36864
    ds_write_b128 v49, v[136:139] offset:40960
    ds_write_b128 v49, v[140:143] offset:45056
    s_waitcnt lgkmcnt(0)
    s_barrier
    s_mov_b32 s100, 0x40000
    s_mov_b32 exec_lo, 0xffff3fff
    s_mov_b32 exec_hi, 0xffff
poll2:
    buffer_load_dwordx2 v[46:47], v45, s[52:55], s99 offen sc0 sc1
    s_waitcnt vmcnt(0)
    v_cmp_ne_u64 vcc, v[46:47], v[40:41]
    s_sub_u32 s100, s100, 1
    s_cbranch_scc1 poll2_d
    s_nop 3
    s_cbranch_vccz poll2_d
    s_sleep 2
    s_branch poll2
poll2_d:
    s_mov_b64 exec, -1
    buffer_load_dwordx2 v[160:161], v252, s[52:55], s64 offen sc1
    buffer_load_dwordx2 v[162:163], v252, s[52:55], s65 offen sc1
    buffer_load_dwordx2 v[164:165], v252, s[52:55], s66 offen sc1
    buffer_load_dwordx2 v[166:167], v252, s[52:55], s67 offen sc1
    buffer_load_dwordx2 v[168:169], v253, s[52:55], s64 offen sc1
    buffer_load_dwordx2 v[170:171], v253, s[52:55], s65 offen sc1
    buffer_load_dwordx2 v[172:173], v253, s[52:55], s66 offen sc1
    buffer_load_dwordx2 v[174:175], v253, s[52:55], s67 offen sc1
    buffer_load_dwordx2 v[176:177], v254, s[52:55], s64 offen sc1
    buffer_load_dwordx2 v[178:179], v254, s[52:55], s65 offen sc1
    buffer_load_dwordx2 v[180:181], v254, s[52:55], s66 offen sc1
    buffer_load_dwordx2 v[182:183], v254, s[52:55], s67 offen sc1
    buffer_load_dwordx2 v[184:185], v255, s[52:55], s64 offen sc1
    buffer_load_dwordx2 v[186:187], v255, s[52:55], s65 offen sc1
    buffer_load_dwordx2 v[188:189], v255, s[52:55], s66 offen sc1
    buffer_load_dwordx2 v[190:191], v255, s[52:55], s67 offen sc1
    s_mov_b32 s26, 10485760
    buffer_load_dword v246, v246, s[52:55], s26 offen sc1
    s_waitcnt vmcnt(0)
    v_cndmask_b32 v160, v160, v161, s[70:71]
    v_cndmask_b32 v161, v161, 0, s[68:69]
    v_cndmask_b32 v162, v162, v163, s[70:71]
    v_cndmask_b32 v163, v163, 0, s[68:69]
    v_cndmask_b32 v164, v164, v165, s[70:71]
    v_cndmask_b32 v165, v165, 0, s[68:69]
    v_cndmask_b32 v166, v166, v167, s[70:71]
    v_cndmask_b32 v167, v167, 0, s[68:69]
    s_nop 1
    v_mfma_f32_16x16x32_bf16 v[196:199], v[168:171], v[224:227], 0
    v_mfma_f32_16x16x32_bf16 v[200:203], v[176:179], v[224:227], 0
    v_mfma_f32_16x16x32_bf16 v[204:207], v[184:187], v[224:227], 0
    v_mfma_f32_16x16x32_bf16 v[192:195], v[160:163], v[224:227], 0
    v_mfma_f32_16x16x32_bf16 v[196:199], v[172:175], v[228:231], v[196:199]
    v_mfma_f32_16x16x32_bf16 v[200:203], v[180:183], v[228:231], v[200:203]
    v_mfma_f32_16x16x32_bf16 v[204:207], v[188:191], v[228:231], v[204:207]
    v_mfma_f32_16x16x32_bf16 v[192:195], v[164:167], v[228:231], v[192:195]
    v_sub_f32 v248, 1.0, v246
    v_cvt_pk_bf16_f32 v248, v248, v248
    v_lshlrev_b32 v248, 16, v248
    ds_write_b32 v53, v248
    s_nop 7
    s_nop 3
    v_mul_f32 v196, v246, v196
    v_mul_f32 v197, v246, v197
    v_mul_f32 v198, v246, v198
    v_mul_f32 v199, v246, v199
    ds_write_b128 v52, v[196:199] offset:1024
    v_mul_f32 v200, v246, v200
    v_mul_f32 v201, v246, v201
    v_mul_f32 v202, v246, v202
    v_mul_f32 v203, v246, v203
    ds_write_b128 v52, v[200:203] offset:2048
    v_mul_f32 v204, v246, v204
    v_mul_f32 v205, v246, v205
    v_mul_f32 v206, v246, v206
    v_mul_f32 v207, v246, v207
    ds_write_b128 v52, v[204:207] offset:3072
    v_mul_f32 v192, v246, v192
    v_mul_f32 v193, v246, v193
    v_mul_f32 v194, v246, v194
    v_mul_f32 v195, v246, v195
    ds_write_b128 v52, v[192:195] offset:0
    s_waitcnt lgkmcnt(0)
    s_barrier
    s_endpgm
k1_exit:
    s_endpgm
.p2align 6
k1_ffn_c:
    s_mov_b32 s52, s22
    s_and_b32 s53, s23, 0xffff
    s_mov_b32 s54, 0xa04000
    s_mov_b32 s55, 0x20000
    s_mov_b32 s36, s22
    s_and_b32 s37, s23, 0xffff
    s_mov_b32 s38, 0xa04000
    s_mov_b32 s39, 0x20000
    s_mov_b32 s48, s64
    s_and_b32 s49, s65, 0xffff
    s_mov_b32 s50, 0x200000
    s_mov_b32 s51, 0x20000
    v_and_b32 v236, 63, v0
    v_and_b32 v237, 15, v236
    v_lshrrev_b32 v238, 4, v236
    v_lshrrev_b32 v239, 1, v237
    v_xor_b32 v239, v239, v238
    v_lshlrev_b32 v239, 4, v239
    v_lshl_add_u32 v224, v237, 7, v239
    v_xor_b32 v225, 64, v224
    v_lshrrev_b32 v239, 2, v237
    v_and_b32 v240, 1, v238
    v_lshl_or_b32 v240, v240, 2, v239
    s_lshl_b32 s26, s3, 1
    v_xor_b32 v240, s26, v240
    v_lshlrev_b32 v240, 5, v240
    v_lshl_add_u32 v241, v238, 3, v239
    v_lshl_add_u32 v240, v241, 8, v240
    v_and_b32 v241, 3, v237
    v_lshl_add_u32 v230, v241, 3, v240
    v_xor_b32 v231, 32, v230
    v_add_u32 v226, 0x10000, v224
    v_add_u32 v227, 0x10000, v225
    v_add_u32 v232, 0x10000, v230
    v_add_u32 v233, 0x10000, v231
    v_add_u32 v228, 0x20000, v224
    v_add_u32 v229, 0x20000, v225
    v_add_u32 v234, 0x20000, v230
    v_add_u32 v235, 0x20000, v231
    v_lshlrev_b32 v244, 4, v236
    s_mul_i32 s26, s24, 56
    s_lshl_b32 s27, s25, 2
    s_add_u32 s26, s26, s27
    s_add_u32 s26, s26, s3
    s_lshl_b32 s28, s26, 10
    s_barrier
    ds_read_b64_tr_b16 v[160:161], v230 offset:16384
    ds_read_b64_tr_b16 v[162:163], v230 offset:17408
    ds_read_b64_tr_b16 v[164:165], v231 offset:16384
    ds_read_b64_tr_b16 v[166:167], v231 offset:17408
    ds_read_b64_tr_b16 v[168:169], v230 offset:24576
    ds_read_b64_tr_b16 v[170:171], v230 offset:25600
    ds_read_b64_tr_b16 v[172:173], v231 offset:24576
    ds_read_b64_tr_b16 v[174:175], v231 offset:25600
    ds_read_b128 v[128:131], v224 offset:0
    ds_read_b128 v[132:135], v224 offset:2048
    ds_read_b128 v[136:139], v224 offset:4096
    ds_read_b128 v[140:143], v224 offset:6144
    ds_read_b128 v[144:147], v224 offset:8192
    ds_read_b128 v[148:151], v224 offset:10240
    ds_read_b128 v[152:155], v224 offset:12288
    ds_read_b128 v[156:159], v224 offset:14336
    s_waitcnt lgkmcnt(0)
    s_barrier
    v_mfma_f32_16x16x32_bf16 v[0:3], v[160:163], v[128:131], 0
    ds_read_b64_tr_b16 v[208:209], v230 offset:32768
    v_mfma_f32_16x16x32_bf16 v[4:7], v[164:167], v[128:131], 0
    ds_read_b64_tr_b16 v[210:211], v230 offset:33792
    v_mfma_f32_16x16x32_bf16 v[12:15], v[172:175], v[128:131], 0
    ds_read_b64_tr_b16 v[212:213], v231 offset:32768
    v_mfma_f32_16x16x32_bf16 v[8:11], v[168:171], v[128:131], 0
    ds_read_b64_tr_b16 v[214:215], v231 offset:33792
    v_mfma_f32_16x16x32_bf16 v[16:19], v[160:163], v[132:135], 0
    ds_read_b64_tr_b16 v[216:217], v230 offset:40960
    v_mfma_f32_16x16x32_bf16 v[20:23], v[164:167], v[132:135], 0
    ds_read_b64_tr_b16 v[218:219], v230 offset:41984
    v_mfma_f32_16x16x32_bf16 v[28:31], v[172:175], v[132:135], 0
    ds_read_b64_tr_b16 v[220:221], v231 offset:40960
    v_mfma_f32_16x16x32_bf16 v[24:27], v[168:171], v[132:135], 0
    ds_read_b64_tr_b16 v[222:223], v231 offset:41984
    v_mfma_f32_16x16x32_bf16 v[32:35], v[160:163], v[136:139], 0
    ds_read_b128 v[176:179], v225 offset:0
    v_mfma_f32_16x16x32_bf16 v[36:39], v[164:167], v[136:139], 0
    ds_read_b128 v[180:183], v225 offset:2048
    v_mfma_f32_16x16x32_bf16 v[44:47], v[172:175], v[136:139], 0
    ds_read_b128 v[184:187], v225 offset:4096
    v_mfma_f32_16x16x32_bf16 v[40:43], v[168:171], v[136:139], 0
    ds_read_b128 v[188:191], v225 offset:6144
    v_mfma_f32_16x16x32_bf16 v[48:51], v[160:163], v[140:143], 0
    ds_read_b128 v[192:195], v225 offset:8192
    v_mfma_f32_16x16x32_bf16 v[52:55], v[164:167], v[140:143], 0
    ds_read_b128 v[196:199], v225 offset:10240
    v_mfma_f32_16x16x32_bf16 v[60:63], v[172:175], v[140:143], 0
    ds_read_b128 v[200:203], v225 offset:12288
    v_mfma_f32_16x16x32_bf16 v[56:59], v[168:171], v[140:143], 0
    ds_read_b128 v[204:207], v225 offset:14336
    v_mfma_f32_16x16x32_bf16 v[64:67], v[160:163], v[144:147], 0
    v_mfma_f32_16x16x32_bf16 v[68:71], v[164:167], v[144:147], 0
    v_mfma_f32_16x16x32_bf16 v[76:79], v[172:175], v[144:147], 0
    v_mfma_f32_16x16x32_bf16 v[72:75], v[168:171], v[144:147], 0
    v_mfma_f32_16x16x32_bf16 v[80:83], v[160:163], v[148:151], 0
    v_mfma_f32_16x16x32_bf16 v[84:87], v[164:167], v[148:151], 0
    v_mfma_f32_16x16x32_bf16 v[92:95], v[172:175], v[148:151], 0
    v_mfma_f32_16x16x32_bf16 v[88:91], v[168:171], v[148:151], 0
    v_mfma_f32_16x16x32_bf16 v[96:99], v[160:163], v[152:155], 0
    v_mfma_f32_16x16x32_bf16 v[100:103], v[164:167], v[152:155], 0
    v_mfma_f32_16x16x32_bf16 v[108:111], v[172:175], v[152:155], 0
    v_mfma_f32_16x16x32_bf16 v[104:107], v[168:171], v[152:155], 0
    v_mfma_f32_16x16x32_bf16 v[112:115], v[160:163], v[156:159], 0
    v_mfma_f32_16x16x32_bf16 v[116:119], v[164:167], v[156:159], 0
    v_mfma_f32_16x16x32_bf16 v[124:127], v[172:175], v[156:159], 0
    v_mfma_f32_16x16x32_bf16 v[120:123], v[168:171], v[156:159], 0
    s_waitcnt lgkmcnt(0)
    s_barrier
    v_mfma_f32_16x16x32_bf16 v[0:3], v[208:211], v[176:179], v[0:3]
    ds_read_b64_tr_b16 v[160:161], v232 offset:0
    v_mfma_f32_16x16x32_bf16 v[4:7], v[212:215], v[176:179], v[4:7]
    ds_read_b64_tr_b16 v[162:163], v232 offset:1024
    v_mfma_f32_16x16x32_bf16 v[12:15], v[220:223], v[176:179], v[12:15]
    ds_read_b64_tr_b16 v[164:165], v233 offset:0
    v_mfma_f32_16x16x32_bf16 v[8:11], v[216:219], v[176:179], v[8:11]
    ds_read_b64_tr_b16 v[166:167], v233 offset:1024
    v_mfma_f32_16x16x32_bf16 v[16:19], v[208:211], v[180:183], v[16:19]
    ds_read_b64_tr_b16 v[168:169], v232 offset:8192
    v_mfma_f32_16x16x32_bf16 v[20:23], v[212:215], v[180:183], v[20:23]
    ds_read_b64_tr_b16 v[170:171], v232 offset:9216
    v_mfma_f32_16x16x32_bf16 v[28:31], v[220:223], v[180:183], v[28:31]
    ds_read_b64_tr_b16 v[172:173], v233 offset:8192
    v_mfma_f32_16x16x32_bf16 v[24:27], v[216:219], v[180:183], v[24:27]
    ds_read_b64_tr_b16 v[174:175], v233 offset:9216
    v_mfma_f32_16x16x32_bf16 v[32:35], v[208:211], v[184:187], v[32:35]
    ds_read_b128 v[128:131], v224 offset:49152
    v_mfma_f32_16x16x32_bf16 v[36:39], v[212:215], v[184:187], v[36:39]
    ds_read_b128 v[132:135], v224 offset:51200
    v_mfma_f32_16x16x32_bf16 v[44:47], v[220:223], v[184:187], v[44:47]
    ds_read_b128 v[136:139], v224 offset:53248
    v_mfma_f32_16x16x32_bf16 v[40:43], v[216:219], v[184:187], v[40:43]
    ds_read_b128 v[140:143], v224 offset:55296
    v_mfma_f32_16x16x32_bf16 v[48:51], v[208:211], v[188:191], v[48:51]
    ds_read_b128 v[144:147], v224 offset:57344
    v_mfma_f32_16x16x32_bf16 v[52:55], v[212:215], v[188:191], v[52:55]
    ds_read_b128 v[148:151], v224 offset:59392
    v_mfma_f32_16x16x32_bf16 v[60:63], v[220:223], v[188:191], v[60:63]
    ds_read_b128 v[152:155], v224 offset:61440
    v_mfma_f32_16x16x32_bf16 v[56:59], v[216:219], v[188:191], v[56:59]
    ds_read_b128 v[156:159], v224 offset:63488
    v_mfma_f32_16x16x32_bf16 v[64:67], v[208:211], v[192:195], v[64:67]
    v_mfma_f32_16x16x32_bf16 v[68:71], v[212:215], v[192:195], v[68:71]
    v_mfma_f32_16x16x32_bf16 v[76:79], v[220:223], v[192:195], v[76:79]
    v_mfma_f32_16x16x32_bf16 v[72:75], v[216:219], v[192:195], v[72:75]
    v_mfma_f32_16x16x32_bf16 v[80:83], v[208:211], v[196:199], v[80:83]
    v_mfma_f32_16x16x32_bf16 v[84:87], v[212:215], v[196:199], v[84:87]
    v_mfma_f32_16x16x32_bf16 v[92:95], v[220:223], v[196:199], v[92:95]
    v_mfma_f32_16x16x32_bf16 v[88:91], v[216:219], v[196:199], v[88:91]
    v_mfma_f32_16x16x32_bf16 v[96:99], v[208:211], v[200:203], v[96:99]
    v_mfma_f32_16x16x32_bf16 v[100:103], v[212:215], v[200:203], v[100:103]
    v_mfma_f32_16x16x32_bf16 v[108:111], v[220:223], v[200:203], v[108:111]
    v_mfma_f32_16x16x32_bf16 v[104:107], v[216:219], v[200:203], v[104:107]
    v_mfma_f32_16x16x32_bf16 v[112:115], v[208:211], v[204:207], v[112:115]
    v_mfma_f32_16x16x32_bf16 v[116:119], v[212:215], v[204:207], v[116:119]
    v_mfma_f32_16x16x32_bf16 v[124:127], v[220:223], v[204:207], v[124:127]
    v_mfma_f32_16x16x32_bf16 v[120:123], v[216:219], v[204:207], v[120:123]
    s_waitcnt lgkmcnt(0)
    s_barrier
    v_mfma_f32_16x16x32_bf16 v[0:3], v[160:163], v[128:131], v[0:3]
    ds_read_b64_tr_b16 v[208:209], v232 offset:16384
    v_mfma_f32_16x16x32_bf16 v[4:7], v[164:167], v[128:131], v[4:7]
    ds_read_b64_tr_b16 v[210:211], v232 offset:17408
    v_mfma_f32_16x16x32_bf16 v[12:15], v[172:175], v[128:131], v[12:15]
    ds_read_b64_tr_b16 v[212:213], v233 offset:16384
    v_mfma_f32_16x16x32_bf16 v[8:11], v[168:171], v[128:131], v[8:11]
    ds_read_b64_tr_b16 v[214:215], v233 offset:17408
    v_mfma_f32_16x16x32_bf16 v[16:19], v[160:163], v[132:135], v[16:19]
    ds_read_b64_tr_b16 v[216:217], v232 offset:24576
    v_mfma_f32_16x16x32_bf16 v[20:23], v[164:167], v[132:135], v[20:23]
    ds_read_b64_tr_b16 v[218:219], v232 offset:25600
    v_mfma_f32_16x16x32_bf16 v[28:31], v[172:175], v[132:135], v[28:31]
    ds_read_b64_tr_b16 v[220:221], v233 offset:24576
    v_mfma_f32_16x16x32_bf16 v[24:27], v[168:171], v[132:135], v[24:27]
    ds_read_b64_tr_b16 v[222:223], v233 offset:25600
    v_mfma_f32_16x16x32_bf16 v[32:35], v[160:163], v[136:139], v[32:35]
    ds_read_b128 v[176:179], v225 offset:49152
    v_mfma_f32_16x16x32_bf16 v[36:39], v[164:167], v[136:139], v[36:39]
    ds_read_b128 v[180:183], v225 offset:51200
    v_mfma_f32_16x16x32_bf16 v[44:47], v[172:175], v[136:139], v[44:47]
    ds_read_b128 v[184:187], v225 offset:53248
    v_mfma_f32_16x16x32_bf16 v[40:43], v[168:171], v[136:139], v[40:43]
    ds_read_b128 v[188:191], v225 offset:55296
    v_mfma_f32_16x16x32_bf16 v[48:51], v[160:163], v[140:143], v[48:51]
    ds_read_b128 v[192:195], v225 offset:57344
    v_mfma_f32_16x16x32_bf16 v[52:55], v[164:167], v[140:143], v[52:55]
    ds_read_b128 v[196:199], v225 offset:59392
    v_mfma_f32_16x16x32_bf16 v[60:63], v[172:175], v[140:143], v[60:63]
    ds_read_b128 v[200:203], v225 offset:61440
    v_mfma_f32_16x16x32_bf16 v[56:59], v[168:171], v[140:143], v[56:59]
    ds_read_b128 v[204:207], v225 offset:63488
    v_mfma_f32_16x16x32_bf16 v[64:67], v[160:163], v[144:147], v[64:67]
    v_mfma_f32_16x16x32_bf16 v[68:71], v[164:167], v[144:147], v[68:71]
    v_mfma_f32_16x16x32_bf16 v[76:79], v[172:175], v[144:147], v[76:79]
    v_mfma_f32_16x16x32_bf16 v[72:75], v[168:171], v[144:147], v[72:75]
    v_mfma_f32_16x16x32_bf16 v[80:83], v[160:163], v[148:151], v[80:83]
    v_mfma_f32_16x16x32_bf16 v[84:87], v[164:167], v[148:151], v[84:87]
    v_mfma_f32_16x16x32_bf16 v[92:95], v[172:175], v[148:151], v[92:95]
    v_mfma_f32_16x16x32_bf16 v[88:91], v[168:171], v[148:151], v[88:91]
    v_mfma_f32_16x16x32_bf16 v[96:99], v[160:163], v[152:155], v[96:99]
    v_mfma_f32_16x16x32_bf16 v[100:103], v[164:167], v[152:155], v[100:103]
    v_mfma_f32_16x16x32_bf16 v[108:111], v[172:175], v[152:155], v[108:111]
    v_mfma_f32_16x16x32_bf16 v[104:107], v[168:171], v[152:155], v[104:107]
    v_mfma_f32_16x16x32_bf16 v[112:115], v[160:163], v[156:159], v[112:115]
    v_mfma_f32_16x16x32_bf16 v[116:119], v[164:167], v[156:159], v[116:119]
    v_mfma_f32_16x16x32_bf16 v[124:127], v[172:175], v[156:159], v[124:127]
    v_mfma_f32_16x16x32_bf16 v[120:123], v[168:171], v[156:159], v[120:123]
    s_waitcnt lgkmcnt(0)
    s_barrier
    v_mfma_f32_16x16x32_bf16 v[0:3], v[208:211], v[176:179], v[0:3]
    ds_read_b64_tr_b16 v[160:161], v232 offset:49152
    v_mfma_f32_16x16x32_bf16 v[4:7], v[212:215], v[176:179], v[4:7]
    ds_read_b64_tr_b16 v[162:163], v232 offset:50176
    v_mfma_f32_16x16x32_bf16 v[12:15], v[220:223], v[176:179], v[12:15]
    ds_read_b64_tr_b16 v[164:165], v233 offset:49152
    v_mfma_f32_16x16x32_bf16 v[8:11], v[216:219], v[176:179], v[8:11]
    ds_read_b64_tr_b16 v[166:167], v233 offset:50176
    v_mfma_f32_16x16x32_bf16 v[16:19], v[208:211], v[180:183], v[16:19]
    ds_read_b64_tr_b16 v[168:169], v232 offset:57344
    v_mfma_f32_16x16x32_bf16 v[20:23], v[212:215], v[180:183], v[20:23]
    ds_read_b64_tr_b16 v[170:171], v232 offset:58368
    v_mfma_f32_16x16x32_bf16 v[28:31], v[220:223], v[180:183], v[28:31]
    ds_read_b64_tr_b16 v[172:173], v233 offset:57344
    v_mfma_f32_16x16x32_bf16 v[24:27], v[216:219], v[180:183], v[24:27]
    ds_read_b64_tr_b16 v[174:175], v233 offset:58368
    v_mfma_f32_16x16x32_bf16 v[32:35], v[208:211], v[184:187], v[32:35]
    ds_read_b128 v[128:131], v226 offset:32768
    v_mfma_f32_16x16x32_bf16 v[36:39], v[212:215], v[184:187], v[36:39]
    ds_read_b128 v[132:135], v226 offset:34816
    v_mfma_f32_16x16x32_bf16 v[44:47], v[220:223], v[184:187], v[44:47]
    ds_read_b128 v[136:139], v226 offset:36864
    v_mfma_f32_16x16x32_bf16 v[40:43], v[216:219], v[184:187], v[40:43]
    ds_read_b128 v[140:143], v226 offset:38912
    v_mfma_f32_16x16x32_bf16 v[48:51], v[208:211], v[188:191], v[48:51]
    ds_read_b128 v[144:147], v226 offset:40960
    v_mfma_f32_16x16x32_bf16 v[52:55], v[212:215], v[188:191], v[52:55]
    ds_read_b128 v[148:151], v226 offset:43008
    v_mfma_f32_16x16x32_bf16 v[60:63], v[220:223], v[188:191], v[60:63]
    ds_read_b128 v[152:155], v226 offset:45056
    v_mfma_f32_16x16x32_bf16 v[56:59], v[216:219], v[188:191], v[56:59]
    ds_read_b128 v[156:159], v226 offset:47104
    v_mfma_f32_16x16x32_bf16 v[64:67], v[208:211], v[192:195], v[64:67]
    v_mfma_f32_16x16x32_bf16 v[68:71], v[212:215], v[192:195], v[68:71]
    v_mfma_f32_16x16x32_bf16 v[76:79], v[220:223], v[192:195], v[76:79]
    v_mfma_f32_16x16x32_bf16 v[72:75], v[216:219], v[192:195], v[72:75]
    v_mfma_f32_16x16x32_bf16 v[80:83], v[208:211], v[196:199], v[80:83]
    v_mfma_f32_16x16x32_bf16 v[84:87], v[212:215], v[196:199], v[84:87]
    v_mfma_f32_16x16x32_bf16 v[92:95], v[220:223], v[196:199], v[92:95]
    v_mfma_f32_16x16x32_bf16 v[88:91], v[216:219], v[196:199], v[88:91]
    v_mfma_f32_16x16x32_bf16 v[96:99], v[208:211], v[200:203], v[96:99]
    v_mfma_f32_16x16x32_bf16 v[100:103], v[212:215], v[200:203], v[100:103]
    v_mfma_f32_16x16x32_bf16 v[108:111], v[220:223], v[200:203], v[108:111]
    v_mfma_f32_16x16x32_bf16 v[104:107], v[216:219], v[200:203], v[104:107]
    v_mfma_f32_16x16x32_bf16 v[112:115], v[208:211], v[204:207], v[112:115]
    v_mfma_f32_16x16x32_bf16 v[116:119], v[212:215], v[204:207], v[116:119]
    v_mfma_f32_16x16x32_bf16 v[124:127], v[220:223], v[204:207], v[124:127]
    v_mfma_f32_16x16x32_bf16 v[120:123], v[216:219], v[204:207], v[120:123]
    s_waitcnt lgkmcnt(0)
    s_barrier
    v_mfma_f32_16x16x32_bf16 v[0:3], v[160:163], v[128:131], v[0:3]
    ds_read_b64_tr_b16 v[208:209], v234 offset:0
    v_mfma_f32_16x16x32_bf16 v[4:7], v[164:167], v[128:131], v[4:7]
    ds_read_b64_tr_b16 v[210:211], v234 offset:1024
    v_mfma_f32_16x16x32_bf16 v[12:15], v[172:175], v[128:131], v[12:15]
    ds_read_b64_tr_b16 v[212:213], v235 offset:0
    v_mfma_f32_16x16x32_bf16 v[8:11], v[168:171], v[128:131], v[8:11]
    ds_read_b64_tr_b16 v[214:215], v235 offset:1024
    v_mfma_f32_16x16x32_bf16 v[16:19], v[160:163], v[132:135], v[16:19]
    ds_read_b64_tr_b16 v[216:217], v234 offset:8192
    v_mfma_f32_16x16x32_bf16 v[20:23], v[164:167], v[132:135], v[20:23]
    ds_read_b64_tr_b16 v[218:219], v234 offset:9216
    v_mfma_f32_16x16x32_bf16 v[28:31], v[172:175], v[132:135], v[28:31]
    ds_read_b64_tr_b16 v[220:221], v235 offset:8192
    v_mfma_f32_16x16x32_bf16 v[24:27], v[168:171], v[132:135], v[24:27]
    ds_read_b64_tr_b16 v[222:223], v235 offset:9216
    v_mfma_f32_16x16x32_bf16 v[32:35], v[160:163], v[136:139], v[32:35]
    ds_read_b128 v[176:179], v227 offset:32768
    v_mfma_f32_16x16x32_bf16 v[36:39], v[164:167], v[136:139], v[36:39]
    ds_read_b128 v[180:183], v227 offset:34816
    v_mfma_f32_16x16x32_bf16 v[44:47], v[172:175], v[136:139], v[44:47]
    ds_read_b128 v[184:187], v227 offset:36864
    v_mfma_f32_16x16x32_bf16 v[40:43], v[168:171], v[136:139], v[40:43]
    ds_read_b128 v[188:191], v227 offset:38912
    v_mfma_f32_16x16x32_bf16 v[48:51], v[160:163], v[140:143], v[48:51]
    ds_read_b128 v[192:195], v227 offset:40960
    v_mfma_f32_16x16x32_bf16 v[52:55], v[164:167], v[140:143], v[52:55]
    ds_read_b128 v[196:199], v227 offset:43008
    v_mfma_f32_16x16x32_bf16 v[60:63], v[172:175], v[140:143], v[60:63]
    ds_read_b128 v[200:203], v227 offset:45056
    v_mfma_f32_16x16x32_bf16 v[56:59], v[168:171], v[140:143], v[56:59]
    ds_read_b128 v[204:207], v227 offset:47104
    v_mfma_f32_16x16x32_bf16 v[64:67], v[160:163], v[144:147], v[64:67]
    v_mfma_f32_16x16x32_bf16 v[68:71], v[164:167], v[144:147], v[68:71]
    v_mfma_f32_16x16x32_bf16 v[76:79], v[172:175], v[144:147], v[76:79]
    v_mfma_f32_16x16x32_bf16 v[72:75], v[168:171], v[144:147], v[72:75]
    v_mfma_f32_16x16x32_bf16 v[80:83], v[160:163], v[148:151], v[80:83]
    v_mfma_f32_16x16x32_bf16 v[84:87], v[164:167], v[148:151], v[84:87]
    v_mfma_f32_16x16x32_bf16 v[92:95], v[172:175], v[148:151], v[92:95]
    v_mfma_f32_16x16x32_bf16 v[88:91], v[168:171], v[148:151], v[88:91]
    v_mfma_f32_16x16x32_bf16 v[96:99], v[160:163], v[152:155], v[96:99]
    v_mfma_f32_16x16x32_bf16 v[100:103], v[164:167], v[152:155], v[100:103]
    v_mfma_f32_16x16x32_bf16 v[108:111], v[172:175], v[152:155], v[108:111]
    v_mfma_f32_16x16x32_bf16 v[104:107], v[168:171], v[152:155], v[104:107]
    v_mfma_f32_16x16x32_bf16 v[112:115], v[160:163], v[156:159], v[112:115]
    v_mfma_f32_16x16x32_bf16 v[116:119], v[164:167], v[156:159], v[116:119]
    v_mfma_f32_16x16x32_bf16 v[124:127], v[172:175], v[156:159], v[124:127]
    v_mfma_f32_16x16x32_bf16 v[120:123], v[168:171], v[156:159], v[120:123]
    s_waitcnt lgkmcnt(0)
    s_barrier
    v_mfma_f32_16x16x32_bf16 v[0:3], v[208:211], v[176:179], v[0:3]
    ds_read_b64_tr_b16 v[160:161], v230 offset:16384
    v_mfma_f32_16x16x32_bf16 v[4:7], v[212:215], v[176:179], v[4:7]
    ds_read_b64_tr_b16 v[162:163], v230 offset:17408
    v_mfma_f32_16x16x32_bf16 v[12:15], v[220:223], v[176:179], v[12:15]
    ds_read_b64_tr_b16 v[164:165], v231 offset:16384
    v_mfma_f32_16x16x32_bf16 v[8:11], v[216:219], v[176:179], v[8:11]
    ds_read_b64_tr_b16 v[166:167], v231 offset:17408
    v_mfma_f32_16x16x32_bf16 v[16:19], v[208:211], v[180:183], v[16:19]
    ds_read_b64_tr_b16 v[168:169], v230 offset:24576
    v_mfma_f32_16x16x32_bf16 v[20:23], v[212:215], v[180:183], v[20:23]
    ds_read_b64_tr_b16 v[170:171], v230 offset:25600
    v_mfma_f32_16x16x32_bf16 v[28:31], v[220:223], v[180:183], v[28:31]
    ds_read_b64_tr_b16 v[172:173], v231 offset:24576
    v_mfma_f32_16x16x32_bf16 v[24:27], v[216:219], v[180:183], v[24:27]
    ds_read_b64_tr_b16 v[174:175], v231 offset:25600
    v_mfma_f32_16x16x32_bf16 v[32:35], v[208:211], v[184:187], v[32:35]
    ds_read_b128 v[128:131], v228 offset:16384
    v_mfma_f32_16x16x32_bf16 v[36:39], v[212:215], v[184:187], v[36:39]
    ds_read_b128 v[132:135], v228 offset:18432
    v_mfma_f32_16x16x32_bf16 v[44:47], v[220:223], v[184:187], v[44:47]
    ds_read_b128 v[136:139], v228 offset:20480
    v_mfma_f32_16x16x32_bf16 v[40:43], v[216:219], v[184:187], v[40:43]
    ds_read_b128 v[140:143], v228 offset:22528
    v_mfma_f32_16x16x32_bf16 v[48:51], v[208:211], v[188:191], v[48:51]
    ds_read_b128 v[144:147], v228 offset:24576
    v_mfma_f32_16x16x32_bf16 v[52:55], v[212:215], v[188:191], v[52:55]
    ds_read_b128 v[148:151], v228 offset:26624
    v_mfma_f32_16x16x32_bf16 v[60:63], v[220:223], v[188:191], v[60:63]
    ds_read_b128 v[152:155], v228 offset:28672
    v_mfma_f32_16x16x32_bf16 v[56:59], v[216:219], v[188:191], v[56:59]
    ds_read_b128 v[156:159], v228 offset:30720
    v_mfma_f32_16x16x32_bf16 v[64:67], v[208:211], v[192:195], v[64:67]
    v_mfma_f32_16x16x32_bf16 v[68:71], v[212:215], v[192:195], v[68:71]
    v_mfma_f32_16x16x32_bf16 v[76:79], v[220:223], v[192:195], v[76:79]
    v_mfma_f32_16x16x32_bf16 v[72:75], v[216:219], v[192:195], v[72:75]
    v_mfma_f32_16x16x32_bf16 v[80:83], v[208:211], v[196:199], v[80:83]
    v_mfma_f32_16x16x32_bf16 v[84:87], v[212:215], v[196:199], v[84:87]
    v_mfma_f32_16x16x32_bf16 v[92:95], v[220:223], v[196:199], v[92:95]
    v_mfma_f32_16x16x32_bf16 v[88:91], v[216:219], v[196:199], v[88:91]
    v_mfma_f32_16x16x32_bf16 v[96:99], v[208:211], v[200:203], v[96:99]
    v_mfma_f32_16x16x32_bf16 v[100:103], v[212:215], v[200:203], v[100:103]
    v_mfma_f32_16x16x32_bf16 v[108:111], v[220:223], v[200:203], v[108:111]
    v_mfma_f32_16x16x32_bf16 v[104:107], v[216:219], v[200:203], v[104:107]
    v_mfma_f32_16x16x32_bf16 v[112:115], v[208:211], v[204:207], v[112:115]
    v_mfma_f32_16x16x32_bf16 v[116:119], v[212:215], v[204:207], v[116:119]
    v_mfma_f32_16x16x32_bf16 v[124:127], v[220:223], v[204:207], v[124:127]
    v_mfma_f32_16x16x32_bf16 v[120:123], v[216:219], v[204:207], v[120:123]
    s_waitcnt lgkmcnt(0)
    s_barrier
    v_mfma_f32_16x16x32_bf16 v[0:3], v[160:163], v[128:131], v[0:3]
    ds_read_b64_tr_b16 v[208:209], v230 offset:32768
    v_mfma_f32_16x16x32_bf16 v[4:7], v[164:167], v[128:131], v[4:7]
    ds_read_b64_tr_b16 v[210:211], v230 offset:33792
    v_mfma_f32_16x16x32_bf16 v[12:15], v[172:175], v[128:131], v[12:15]
    ds_read_b64_tr_b16 v[212:213], v231 offset:32768
    v_mfma_f32_16x16x32_bf16 v[8:11], v[168:171], v[128:131], v[8:11]
    ds_read_b64_tr_b16 v[214:215], v231 offset:33792
    v_mfma_f32_16x16x32_bf16 v[16:19], v[160:163], v[132:135], v[16:19]
    ds_read_b64_tr_b16 v[216:217], v230 offset:40960
    v_mfma_f32_16x16x32_bf16 v[20:23], v[164:167], v[132:135], v[20:23]
    ds_read_b64_tr_b16 v[218:219], v230 offset:41984
    v_mfma_f32_16x16x32_bf16 v[28:31], v[172:175], v[132:135], v[28:31]
    ds_read_b64_tr_b16 v[220:221], v231 offset:40960
    v_mfma_f32_16x16x32_bf16 v[24:27], v[168:171], v[132:135], v[24:27]
    ds_read_b64_tr_b16 v[222:223], v231 offset:41984
    v_mfma_f32_16x16x32_bf16 v[32:35], v[160:163], v[136:139], v[32:35]
    ds_read_b128 v[176:179], v229 offset:16384
    v_mfma_f32_16x16x32_bf16 v[36:39], v[164:167], v[136:139], v[36:39]
    ds_read_b128 v[180:183], v229 offset:18432
    v_mfma_f32_16x16x32_bf16 v[44:47], v[172:175], v[136:139], v[44:47]
    ds_read_b128 v[184:187], v229 offset:20480
    v_mfma_f32_16x16x32_bf16 v[40:43], v[168:171], v[136:139], v[40:43]
    ds_read_b128 v[188:191], v229 offset:22528
    v_mfma_f32_16x16x32_bf16 v[48:51], v[160:163], v[140:143], v[48:51]
    ds_read_b128 v[192:195], v229 offset:24576
    v_mfma_f32_16x16x32_bf16 v[52:55], v[164:167], v[140:143], v[52:55]
    ds_read_b128 v[196:199], v229 offset:26624
    v_mfma_f32_16x16x32_bf16 v[60:63], v[172:175], v[140:143], v[60:63]
    ds_read_b128 v[200:203], v229 offset:28672
    v_mfma_f32_16x16x32_bf16 v[56:59], v[168:171], v[140:143], v[56:59]
    ds_read_b128 v[204:207], v229 offset:30720
    v_mfma_f32_16x16x32_bf16 v[64:67], v[160:163], v[144:147], v[64:67]
    v_mfma_f32_16x16x32_bf16 v[68:71], v[164:167], v[144:147], v[68:71]
    v_mfma_f32_16x16x32_bf16 v[76:79], v[172:175], v[144:147], v[76:79]
    v_mfma_f32_16x16x32_bf16 v[72:75], v[168:171], v[144:147], v[72:75]
    v_mfma_f32_16x16x32_bf16 v[80:83], v[160:163], v[148:151], v[80:83]
    v_mfma_f32_16x16x32_bf16 v[84:87], v[164:167], v[148:151], v[84:87]
    v_mfma_f32_16x16x32_bf16 v[92:95], v[172:175], v[148:151], v[92:95]
    v_mfma_f32_16x16x32_bf16 v[88:91], v[168:171], v[148:151], v[88:91]
    v_mfma_f32_16x16x32_bf16 v[96:99], v[160:163], v[152:155], v[96:99]
    v_mfma_f32_16x16x32_bf16 v[100:103], v[164:167], v[152:155], v[100:103]
    v_mfma_f32_16x16x32_bf16 v[108:111], v[172:175], v[152:155], v[108:111]
    v_mfma_f32_16x16x32_bf16 v[104:107], v[168:171], v[152:155], v[104:107]
    v_mfma_f32_16x16x32_bf16 v[112:115], v[160:163], v[156:159], v[112:115]
    v_mfma_f32_16x16x32_bf16 v[116:119], v[164:167], v[156:159], v[116:119]
    v_mfma_f32_16x16x32_bf16 v[124:127], v[172:175], v[156:159], v[124:127]
    v_mfma_f32_16x16x32_bf16 v[120:123], v[168:171], v[156:159], v[120:123]
    s_waitcnt lgkmcnt(0)
    s_barrier
    v_mfma_f32_16x16x32_bf16 v[0:3], v[208:211], v[176:179], v[0:3]
    ds_read_b64_tr_b16 v[160:161], v232 offset:0
    v_mfma_f32_16x16x32_bf16 v[4:7], v[212:215], v[176:179], v[4:7]
    ds_read_b64_tr_b16 v[162:163], v232 offset:1024
    v_mfma_f32_16x16x32_bf16 v[12:15], v[220:223], v[176:179], v[12:15]
    ds_read_b64_tr_b16 v[164:165], v233 offset:0
    v_mfma_f32_16x16x32_bf16 v[8:11], v[216:219], v[176:179], v[8:11]
    ds_read_b64_tr_b16 v[166:167], v233 offset:1024
    v_mfma_f32_16x16x32_bf16 v[16:19], v[208:211], v[180:183], v[16:19]
    ds_read_b64_tr_b16 v[168:169], v232 offset:8192
    v_mfma_f32_16x16x32_bf16 v[20:23], v[212:215], v[180:183], v[20:23]
    ds_read_b64_tr_b16 v[170:171], v232 offset:9216
    v_mfma_f32_16x16x32_bf16 v[28:31], v[220:223], v[180:183], v[28:31]
    ds_read_b64_tr_b16 v[172:173], v233 offset:8192
    v_mfma_f32_16x16x32_bf16 v[24:27], v[216:219], v[180:183], v[24:27]
    ds_read_b64_tr_b16 v[174:175], v233 offset:9216
    v_mfma_f32_16x16x32_bf16 v[32:35], v[208:211], v[184:187], v[32:35]
    ds_read_b128 v[128:131], v224 offset:0
    v_mfma_f32_16x16x32_bf16 v[36:39], v[212:215], v[184:187], v[36:39]
    ds_read_b128 v[132:135], v224 offset:2048
    v_mfma_f32_16x16x32_bf16 v[44:47], v[220:223], v[184:187], v[44:47]
    ds_read_b128 v[136:139], v224 offset:4096
    v_mfma_f32_16x16x32_bf16 v[40:43], v[216:219], v[184:187], v[40:43]
    ds_read_b128 v[140:143], v224 offset:6144
    v_mfma_f32_16x16x32_bf16 v[48:51], v[208:211], v[188:191], v[48:51]
    ds_read_b128 v[144:147], v224 offset:8192
    v_mfma_f32_16x16x32_bf16 v[52:55], v[212:215], v[188:191], v[52:55]
    ds_read_b128 v[148:151], v224 offset:10240
    v_mfma_f32_16x16x32_bf16 v[60:63], v[220:223], v[188:191], v[60:63]
    ds_read_b128 v[152:155], v224 offset:12288
    v_mfma_f32_16x16x32_bf16 v[56:59], v[216:219], v[188:191], v[56:59]
    ds_read_b128 v[156:159], v224 offset:14336
    v_mfma_f32_16x16x32_bf16 v[64:67], v[208:211], v[192:195], v[64:67]
    v_mfma_f32_16x16x32_bf16 v[68:71], v[212:215], v[192:195], v[68:71]
    v_mfma_f32_16x16x32_bf16 v[76:79], v[220:223], v[192:195], v[76:79]
    v_mfma_f32_16x16x32_bf16 v[72:75], v[216:219], v[192:195], v[72:75]
    v_mfma_f32_16x16x32_bf16 v[80:83], v[208:211], v[196:199], v[80:83]
    v_mfma_f32_16x16x32_bf16 v[84:87], v[212:215], v[196:199], v[84:87]
    v_mfma_f32_16x16x32_bf16 v[92:95], v[220:223], v[196:199], v[92:95]
    v_mfma_f32_16x16x32_bf16 v[88:91], v[216:219], v[196:199], v[88:91]
    v_mfma_f32_16x16x32_bf16 v[96:99], v[208:211], v[200:203], v[96:99]
    v_mfma_f32_16x16x32_bf16 v[100:103], v[212:215], v[200:203], v[100:103]
    v_mfma_f32_16x16x32_bf16 v[108:111], v[220:223], v[200:203], v[108:111]
    v_mfma_f32_16x16x32_bf16 v[104:107], v[216:219], v[200:203], v[104:107]
    v_mfma_f32_16x16x32_bf16 v[112:115], v[208:211], v[204:207], v[112:115]
    v_mfma_f32_16x16x32_bf16 v[116:119], v[212:215], v[204:207], v[116:119]
    v_mfma_f32_16x16x32_bf16 v[124:127], v[220:223], v[204:207], v[124:127]
    v_mfma_f32_16x16x32_bf16 v[120:123], v[216:219], v[204:207], v[120:123]
    s_waitcnt lgkmcnt(0)
    s_barrier
    v_mfma_f32_16x16x32_bf16 v[0:3], v[160:163], v[128:131], v[0:3]
    ds_read_b64_tr_b16 v[208:209], v232 offset:16384
    v_mfma_f32_16x16x32_bf16 v[4:7], v[164:167], v[128:131], v[4:7]
    ds_read_b64_tr_b16 v[210:211], v232 offset:17408
    v_mfma_f32_16x16x32_bf16 v[12:15], v[172:175], v[128:131], v[12:15]
    ds_read_b64_tr_b16 v[212:213], v233 offset:16384
    v_mfma_f32_16x16x32_bf16 v[8:11], v[168:171], v[128:131], v[8:11]
    ds_read_b64_tr_b16 v[214:215], v233 offset:17408
    v_mfma_f32_16x16x32_bf16 v[16:19], v[160:163], v[132:135], v[16:19]
    ds_read_b64_tr_b16 v[216:217], v232 offset:24576
    v_mfma_f32_16x16x32_bf16 v[20:23], v[164:167], v[132:135], v[20:23]
    ds_read_b64_tr_b16 v[218:219], v232 offset:25600
    v_mfma_f32_16x16x32_bf16 v[28:31], v[172:175], v[132:135], v[28:31]
    ds_read_b64_tr_b16 v[220:221], v233 offset:24576
    v_mfma_f32_16x16x32_bf16 v[24:27], v[168:171], v[132:135], v[24:27]
    ds_read_b64_tr_b16 v[222:223], v233 offset:25600
    v_mfma_f32_16x16x32_bf16 v[32:35], v[160:163], v[136:139], v[32:35]
    ds_read_b128 v[176:179], v225 offset:0
    v_mfma_f32_16x16x32_bf16 v[36:39], v[164:167], v[136:139], v[36:39]
    ds_read_b128 v[180:183], v225 offset:2048
    v_mfma_f32_16x16x32_bf16 v[44:47], v[172:175], v[136:139], v[44:47]
    ds_read_b128 v[184:187], v225 offset:4096
    v_mfma_f32_16x16x32_bf16 v[40:43], v[168:171], v[136:139], v[40:43]
    ds_read_b128 v[188:191], v225 offset:6144
    v_mfma_f32_16x16x32_bf16 v[48:51], v[160:163], v[140:143], v[48:51]
    ds_read_b128 v[192:195], v225 offset:8192
    v_mfma_f32_16x16x32_bf16 v[52:55], v[164:167], v[140:143], v[52:55]
    ds_read_b128 v[196:199], v225 offset:10240
    v_mfma_f32_16x16x32_bf16 v[60:63], v[172:175], v[140:143], v[60:63]
    ds_read_b128 v[200:203], v225 offset:12288
    v_mfma_f32_16x16x32_bf16 v[56:59], v[168:171], v[140:143], v[56:59]
    ds_read_b128 v[204:207], v225 offset:14336
    v_mfma_f32_16x16x32_bf16 v[64:67], v[160:163], v[144:147], v[64:67]
    v_mfma_f32_16x16x32_bf16 v[68:71], v[164:167], v[144:147], v[68:71]
    v_mfma_f32_16x16x32_bf16 v[76:79], v[172:175], v[144:147], v[76:79]
    v_mfma_f32_16x16x32_bf16 v[72:75], v[168:171], v[144:147], v[72:75]
    v_mfma_f32_16x16x32_bf16 v[80:83], v[160:163], v[148:151], v[80:83]
    v_mfma_f32_16x16x32_bf16 v[84:87], v[164:167], v[148:151], v[84:87]
    v_mfma_f32_16x16x32_bf16 v[92:95], v[172:175], v[148:151], v[92:95]
    v_mfma_f32_16x16x32_bf16 v[88:91], v[168:171], v[148:151], v[88:91]
    v_mfma_f32_16x16x32_bf16 v[96:99], v[160:163], v[152:155], v[96:99]
    v_mfma_f32_16x16x32_bf16 v[100:103], v[164:167], v[152:155], v[100:103]
    v_mfma_f32_16x16x32_bf16 v[108:111], v[172:175], v[152:155], v[108:111]
    v_mfma_f32_16x16x32_bf16 v[104:107], v[168:171], v[152:155], v[104:107]
    v_mfma_f32_16x16x32_bf16 v[112:115], v[160:163], v[156:159], v[112:115]
    v_mfma_f32_16x16x32_bf16 v[116:119], v[164:167], v[156:159], v[116:119]
    v_mfma_f32_16x16x32_bf16 v[124:127], v[172:175], v[156:159], v[124:127]
    v_mfma_f32_16x16x32_bf16 v[120:123], v[168:171], v[156:159], v[120:123]
    s_waitcnt lgkmcnt(0)
    s_barrier
    v_mfma_f32_16x16x32_bf16 v[0:3], v[208:211], v[176:179], v[0:3]
    ds_read_b64_tr_b16 v[160:161], v232 offset:49152
    v_mfma_f32_16x16x32_bf16 v[4:7], v[212:215], v[176:179], v[4:7]
    ds_read_b64_tr_b16 v[162:163], v232 offset:50176
    v_mfma_f32_16x16x32_bf16 v[12:15], v[220:223], v[176:179], v[12:15]
    ds_read_b64_tr_b16 v[164:165], v233 offset:49152
    v_mfma_f32_16x16x32_bf16 v[8:11], v[216:219], v[176:179], v[8:11]
    ds_read_b64_tr_b16 v[166:167], v233 offset:50176
    v_mfma_f32_16x16x32_bf16 v[16:19], v[208:211], v[180:183], v[16:19]
    ds_read_b64_tr_b16 v[168:169], v232 offset:57344
    v_mfma_f32_16x16x32_bf16 v[20:23], v[212:215], v[180:183], v[20:23]
    ds_read_b64_tr_b16 v[170:171], v232 offset:58368
    v_mfma_f32_16x16x32_bf16 v[28:31], v[220:223], v[180:183], v[28:31]
    ds_read_b64_tr_b16 v[172:173], v233 offset:57344
    v_mfma_f32_16x16x32_bf16 v[24:27], v[216:219], v[180:183], v[24:27]
    ds_read_b64_tr_b16 v[174:175], v233 offset:58368
    v_mfma_f32_16x16x32_bf16 v[32:35], v[208:211], v[184:187], v[32:35]
    ds_read_b128 v[128:131], v224 offset:49152
    v_mfma_f32_16x16x32_bf16 v[36:39], v[212:215], v[184:187], v[36:39]
    ds_read_b128 v[132:135], v224 offset:51200
    v_mfma_f32_16x16x32_bf16 v[44:47], v[220:223], v[184:187], v[44:47]
    ds_read_b128 v[136:139], v224 offset:53248
    v_mfma_f32_16x16x32_bf16 v[40:43], v[216:219], v[184:187], v[40:43]
    ds_read_b128 v[140:143], v224 offset:55296
    v_mfma_f32_16x16x32_bf16 v[48:51], v[208:211], v[188:191], v[48:51]
    ds_read_b128 v[144:147], v224 offset:57344
    v_mfma_f32_16x16x32_bf16 v[52:55], v[212:215], v[188:191], v[52:55]
    ds_read_b128 v[148:151], v224 offset:59392
    v_mfma_f32_16x16x32_bf16 v[60:63], v[220:223], v[188:191], v[60:63]
    ds_read_b128 v[152:155], v224 offset:61440
    v_mfma_f32_16x16x32_bf16 v[56:59], v[216:219], v[188:191], v[56:59]
    ds_read_b128 v[156:159], v224 offset:63488
    v_mfma_f32_16x16x32_bf16 v[64:67], v[208:211], v[192:195], v[64:67]
    v_mfma_f32_16x16x32_bf16 v[68:71], v[212:215], v[192:195], v[68:71]
    v_mfma_f32_16x16x32_bf16 v[76:79], v[220:223], v[192:195], v[76:79]
    v_mfma_f32_16x16x32_bf16 v[72:75], v[216:219], v[192:195], v[72:75]
    v_mfma_f32_16x16x32_bf16 v[80:83], v[208:211], v[196:199], v[80:83]
    v_mfma_f32_16x16x32_bf16 v[84:87], v[212:215], v[196:199], v[84:87]
    v_mfma_f32_16x16x32_bf16 v[92:95], v[220:223], v[196:199], v[92:95]
    v_mfma_f32_16x16x32_bf16 v[88:91], v[216:219], v[196:199], v[88:91]
    v_mfma_f32_16x16x32_bf16 v[96:99], v[208:211], v[200:203], v[96:99]
    v_mfma_f32_16x16x32_bf16 v[100:103], v[212:215], v[200:203], v[100:103]
    v_mfma_f32_16x16x32_bf16 v[108:111], v[220:223], v[200:203], v[108:111]
    v_mfma_f32_16x16x32_bf16 v[104:107], v[216:219], v[200:203], v[104:107]
    v_mfma_f32_16x16x32_bf16 v[112:115], v[208:211], v[204:207], v[112:115]
    v_mfma_f32_16x16x32_bf16 v[116:119], v[212:215], v[204:207], v[116:119]
    v_mfma_f32_16x16x32_bf16 v[124:127], v[220:223], v[204:207], v[124:127]
    v_mfma_f32_16x16x32_bf16 v[120:123], v[216:219], v[204:207], v[120:123]
    s_waitcnt lgkmcnt(0)
    s_barrier
    v_mfma_f32_16x16x32_bf16 v[0:3], v[160:163], v[128:131], v[0:3]
    ds_read_b64_tr_b16 v[208:209], v234 offset:0
    v_mfma_f32_16x16x32_bf16 v[4:7], v[164:167], v[128:131], v[4:7]
    ds_read_b64_tr_b16 v[210:211], v234 offset:1024
    v_mfma_f32_16x16x32_bf16 v[12:15], v[172:175], v[128:131], v[12:15]
    ds_read_b64_tr_b16 v[212:213], v235 offset:0
    v_mfma_f32_16x16x32_bf16 v[8:11], v[168:171], v[128:131], v[8:11]
    ds_read_b64_tr_b16 v[214:215], v235 offset:1024
    v_mfma_f32_16x16x32_bf16 v[16:19], v[160:163], v[132:135], v[16:19]
    ds_read_b64_tr_b16 v[216:217], v234 offset:8192
    v_mfma_f32_16x16x32_bf16 v[20:23], v[164:167], v[132:135], v[20:23]
    ds_read_b64_tr_b16 v[218:219], v234 offset:9216
    v_mfma_f32_16x16x32_bf16 v[28:31], v[172:175], v[132:135], v[28:31]
    ds_read_b64_tr_b16 v[220:221], v235 offset:8192
    v_mfma_f32_16x16x32_bf16 v[24:27], v[168:171], v[132:135], v[24:27]
    ds_read_b64_tr_b16 v[222:223], v235 offset:9216
    v_mfma_f32_16x16x32_bf16 v[32:35], v[160:163], v[136:139], v[32:35]
    ds_read_b128 v[176:179], v225 offset:49152
    v_mfma_f32_16x16x32_bf16 v[36:39], v[164:167], v[136:139], v[36:39]
    ds_read_b128 v[180:183], v225 offset:51200
    v_mfma_f32_16x16x32_bf16 v[44:47], v[172:175], v[136:139], v[44:47]
    ds_read_b128 v[184:187], v225 offset:53248
    v_mfma_f32_16x16x32_bf16 v[40:43], v[168:171], v[136:139], v[40:43]
    ds_read_b128 v[188:191], v225 offset:55296
    v_mfma_f32_16x16x32_bf16 v[48:51], v[160:163], v[140:143], v[48:51]
    ds_read_b128 v[192:195], v225 offset:57344
    v_mfma_f32_16x16x32_bf16 v[52:55], v[164:167], v[140:143], v[52:55]
    ds_read_b128 v[196:199], v225 offset:59392
    v_mfma_f32_16x16x32_bf16 v[60:63], v[172:175], v[140:143], v[60:63]
    ds_read_b128 v[200:203], v225 offset:61440
    v_mfma_f32_16x16x32_bf16 v[56:59], v[168:171], v[140:143], v[56:59]
    ds_read_b128 v[204:207], v225 offset:63488
    v_mfma_f32_16x16x32_bf16 v[64:67], v[160:163], v[144:147], v[64:67]
    v_mfma_f32_16x16x32_bf16 v[68:71], v[164:167], v[144:147], v[68:71]
    v_mfma_f32_16x16x32_bf16 v[76:79], v[172:175], v[144:147], v[76:79]
    v_mfma_f32_16x16x32_bf16 v[72:75], v[168:171], v[144:147], v[72:75]
    v_mfma_f32_16x16x32_bf16 v[80:83], v[160:163], v[148:151], v[80:83]
    v_mfma_f32_16x16x32_bf16 v[84:87], v[164:167], v[148:151], v[84:87]
    v_mfma_f32_16x16x32_bf16 v[92:95], v[172:175], v[148:151], v[92:95]
    v_mfma_f32_16x16x32_bf16 v[88:91], v[168:171], v[148:151], v[88:91]
    v_mfma_f32_16x16x32_bf16 v[96:99], v[160:163], v[152:155], v[96:99]
    v_mfma_f32_16x16x32_bf16 v[100:103], v[164:167], v[152:155], v[100:103]
    v_mfma_f32_16x16x32_bf16 v[108:111], v[172:175], v[152:155], v[108:111]
    v_mfma_f32_16x16x32_bf16 v[104:107], v[168:171], v[152:155], v[104:107]
    v_mfma_f32_16x16x32_bf16 v[112:115], v[160:163], v[156:159], v[112:115]
    v_mfma_f32_16x16x32_bf16 v[116:119], v[164:167], v[156:159], v[116:119]
    v_mfma_f32_16x16x32_bf16 v[124:127], v[172:175], v[156:159], v[124:127]
    v_mfma_f32_16x16x32_bf16 v[120:123], v[168:171], v[156:159], v[120:123]
    s_waitcnt lgkmcnt(0)
    s_barrier
    v_mfma_f32_16x16x32_bf16 v[0:3], v[208:211], v[176:179], v[0:3]
    ds_read_b64_tr_b16 v[160:161], v230 offset:16384
    v_mfma_f32_16x16x32_bf16 v[4:7], v[212:215], v[176:179], v[4:7]
    ds_read_b64_tr_b16 v[162:163], v230 offset:17408
    v_mfma_f32_16x16x32_bf16 v[12:15], v[220:223], v[176:179], v[12:15]
    ds_read_b64_tr_b16 v[164:165], v231 offset:16384
    v_mfma_f32_16x16x32_bf16 v[8:11], v[216:219], v[176:179], v[8:11]
    ds_read_b64_tr_b16 v[166:167], v231 offset:17408
    v_mfma_f32_16x16x32_bf16 v[16:19], v[208:211], v[180:183], v[16:19]
    ds_read_b64_tr_b16 v[168:169], v230 offset:24576
    v_mfma_f32_16x16x32_bf16 v[20:23], v[212:215], v[180:183], v[20:23]
    ds_read_b64_tr_b16 v[170:171], v230 offset:25600
    v_mfma_f32_16x16x32_bf16 v[28:31], v[220:223], v[180:183], v[28:31]
    ds_read_b64_tr_b16 v[172:173], v231 offset:24576
    v_mfma_f32_16x16x32_bf16 v[24:27], v[216:219], v[180:183], v[24:27]
    ds_read_b64_tr_b16 v[174:175], v231 offset:25600
    v_mfma_f32_16x16x32_bf16 v[32:35], v[208:211], v[184:187], v[32:35]
    ds_read_b128 v[128:131], v226 offset:32768
    v_mfma_f32_16x16x32_bf16 v[36:39], v[212:215], v[184:187], v[36:39]
    ds_read_b128 v[132:135], v226 offset:34816
    v_mfma_f32_16x16x32_bf16 v[44:47], v[220:223], v[184:187], v[44:47]
    ds_read_b128 v[136:139], v226 offset:36864
    v_mfma_f32_16x16x32_bf16 v[40:43], v[216:219], v[184:187], v[40:43]
    ds_read_b128 v[140:143], v226 offset:38912
    v_mfma_f32_16x16x32_bf16 v[48:51], v[208:211], v[188:191], v[48:51]
    ds_read_b128 v[144:147], v226 offset:40960
    v_mfma_f32_16x16x32_bf16 v[52:55], v[212:215], v[188:191], v[52:55]
    ds_read_b128 v[148:151], v226 offset:43008
    v_mfma_f32_16x16x32_bf16 v[60:63], v[220:223], v[188:191], v[60:63]
    ds_read_b128 v[152:155], v226 offset:45056
    v_mfma_f32_16x16x32_bf16 v[56:59], v[216:219], v[188:191], v[56:59]
    ds_read_b128 v[156:159], v226 offset:47104
    v_mfma_f32_16x16x32_bf16 v[64:67], v[208:211], v[192:195], v[64:67]
    v_mfma_f32_16x16x32_bf16 v[68:71], v[212:215], v[192:195], v[68:71]
    v_mfma_f32_16x16x32_bf16 v[76:79], v[220:223], v[192:195], v[76:79]
    v_mfma_f32_16x16x32_bf16 v[72:75], v[216:219], v[192:195], v[72:75]
    v_mfma_f32_16x16x32_bf16 v[80:83], v[208:211], v[196:199], v[80:83]
    v_mfma_f32_16x16x32_bf16 v[84:87], v[212:215], v[196:199], v[84:87]
    v_mfma_f32_16x16x32_bf16 v[92:95], v[220:223], v[196:199], v[92:95]
    v_mfma_f32_16x16x32_bf16 v[88:91], v[216:219], v[196:199], v[88:91]
    v_mfma_f32_16x16x32_bf16 v[96:99], v[208:211], v[200:203], v[96:99]
    v_mfma_f32_16x16x32_bf16 v[100:103], v[212:215], v[200:203], v[100:103]
    v_mfma_f32_16x16x32_bf16 v[108:111], v[220:223], v[200:203], v[108:111]
    v_mfma_f32_16x16x32_bf16 v[104:107], v[216:219], v[200:203], v[104:107]
    v_mfma_f32_16x16x32_bf16 v[112:115], v[208:211], v[204:207], v[112:115]
    v_mfma_f32_16x16x32_bf16 v[116:119], v[212:215], v[204:207], v[116:119]
    v_mfma_f32_16x16x32_bf16 v[124:127], v[220:223], v[204:207], v[124:127]
    v_mfma_f32_16x16x32_bf16 v[120:123], v[216:219], v[204:207], v[120:123]
    s_waitcnt lgkmcnt(0)
    s_barrier
    v_mfma_f32_16x16x32_bf16 v[0:3], v[160:163], v[128:131], v[0:3]
    ds_read_b64_tr_b16 v[208:209], v230 offset:32768
    v_mfma_f32_16x16x32_bf16 v[4:7], v[164:167], v[128:131], v[4:7]
    ds_read_b64_tr_b16 v[210:211], v230 offset:33792
    v_mfma_f32_16x16x32_bf16 v[12:15], v[172:175], v[128:131], v[12:15]
    ds_read_b64_tr_b16 v[212:213], v231 offset:32768
    v_mfma_f32_16x16x32_bf16 v[8:11], v[168:171], v[128:131], v[8:11]
    ds_read_b64_tr_b16 v[214:215], v231 offset:33792
    v_mfma_f32_16x16x32_bf16 v[16:19], v[160:163], v[132:135], v[16:19]
    ds_read_b64_tr_b16 v[216:217], v230 offset:40960
    v_mfma_f32_16x16x32_bf16 v[20:23], v[164:167], v[132:135], v[20:23]
    ds_read_b64_tr_b16 v[218:219], v230 offset:41984
    v_mfma_f32_16x16x32_bf16 v[28:31], v[172:175], v[132:135], v[28:31]
    ds_read_b64_tr_b16 v[220:221], v231 offset:40960
    v_mfma_f32_16x16x32_bf16 v[24:27], v[168:171], v[132:135], v[24:27]
    ds_read_b64_tr_b16 v[222:223], v231 offset:41984
    v_mfma_f32_16x16x32_bf16 v[32:35], v[160:163], v[136:139], v[32:35]
    ds_read_b128 v[176:179], v227 offset:32768
    v_mfma_f32_16x16x32_bf16 v[36:39], v[164:167], v[136:139], v[36:39]
    ds_read_b128 v[180:183], v227 offset:34816
    v_mfma_f32_16x16x32_bf16 v[44:47], v[172:175], v[136:139], v[44:47]
    ds_read_b128 v[184:187], v227 offset:36864
    v_mfma_f32_16x16x32_bf16 v[40:43], v[168:171], v[136:139], v[40:43]
    ds_read_b128 v[188:191], v227 offset:38912
    v_mfma_f32_16x16x32_bf16 v[48:51], v[160:163], v[140:143], v[48:51]
    ds_read_b128 v[192:195], v227 offset:40960
    v_mfma_f32_16x16x32_bf16 v[52:55], v[164:167], v[140:143], v[52:55]
    ds_read_b128 v[196:199], v227 offset:43008
    v_mfma_f32_16x16x32_bf16 v[60:63], v[172:175], v[140:143], v[60:63]
    ds_read_b128 v[200:203], v227 offset:45056
    v_mfma_f32_16x16x32_bf16 v[56:59], v[168:171], v[140:143], v[56:59]
    ds_read_b128 v[204:207], v227 offset:47104
    v_mfma_f32_16x16x32_bf16 v[64:67], v[160:163], v[144:147], v[64:67]
    v_mfma_f32_16x16x32_bf16 v[68:71], v[164:167], v[144:147], v[68:71]
    v_mfma_f32_16x16x32_bf16 v[76:79], v[172:175], v[144:147], v[76:79]
    v_mfma_f32_16x16x32_bf16 v[72:75], v[168:171], v[144:147], v[72:75]
    v_mfma_f32_16x16x32_bf16 v[80:83], v[160:163], v[148:151], v[80:83]
    v_mfma_f32_16x16x32_bf16 v[84:87], v[164:167], v[148:151], v[84:87]
    v_mfma_f32_16x16x32_bf16 v[92:95], v[172:175], v[148:151], v[92:95]
    v_mfma_f32_16x16x32_bf16 v[88:91], v[168:171], v[148:151], v[88:91]
    v_mfma_f32_16x16x32_bf16 v[96:99], v[160:163], v[152:155], v[96:99]
    v_mfma_f32_16x16x32_bf16 v[100:103], v[164:167], v[152:155], v[100:103]
    v_mfma_f32_16x16x32_bf16 v[108:111], v[172:175], v[152:155], v[108:111]
    v_mfma_f32_16x16x32_bf16 v[104:107], v[168:171], v[152:155], v[104:107]
    v_mfma_f32_16x16x32_bf16 v[112:115], v[160:163], v[156:159], v[112:115]
    v_mfma_f32_16x16x32_bf16 v[116:119], v[164:167], v[156:159], v[116:119]
    v_mfma_f32_16x16x32_bf16 v[124:127], v[172:175], v[156:159], v[124:127]
    v_mfma_f32_16x16x32_bf16 v[120:123], v[168:171], v[156:159], v[120:123]
    s_waitcnt lgkmcnt(0)
    s_barrier
    v_mfma_f32_16x16x32_bf16 v[0:3], v[208:211], v[176:179], v[0:3]
    ds_read_b64_tr_b16 v[160:161], v232 offset:0
    v_mfma_f32_16x16x32_bf16 v[4:7], v[212:215], v[176:179], v[4:7]
    ds_read_b64_tr_b16 v[162:163], v232 offset:1024
    v_mfma_f32_16x16x32_bf16 v[12:15], v[220:223], v[176:179], v[12:15]
    ds_read_b64_tr_b16 v[164:165], v233 offset:0
    v_mfma_f32_16x16x32_bf16 v[8:11], v[216:219], v[176:179], v[8:11]
    ds_read_b64_tr_b16 v[166:167], v233 offset:1024
    v_mfma_f32_16x16x32_bf16 v[16:19], v[208:211], v[180:183], v[16:19]
    ds_read_b64_tr_b16 v[168:169], v232 offset:8192
    v_mfma_f32_16x16x32_bf16 v[20:23], v[212:215], v[180:183], v[20:23]
    ds_read_b64_tr_b16 v[170:171], v232 offset:9216
    v_mfma_f32_16x16x32_bf16 v[28:31], v[220:223], v[180:183], v[28:31]
    ds_read_b64_tr_b16 v[172:173], v233 offset:8192
    v_mfma_f32_16x16x32_bf16 v[24:27], v[216:219], v[180:183], v[24:27]
    ds_read_b64_tr_b16 v[174:175], v233 offset:9216
    v_mfma_f32_16x16x32_bf16 v[32:35], v[208:211], v[184:187], v[32:35]
    ds_read_b128 v[128:131], v228 offset:16384
    v_mfma_f32_16x16x32_bf16 v[36:39], v[212:215], v[184:187], v[36:39]
    ds_read_b128 v[132:135], v228 offset:18432
    v_mfma_f32_16x16x32_bf16 v[44:47], v[220:223], v[184:187], v[44:47]
    ds_read_b128 v[136:139], v228 offset:20480
    v_mfma_f32_16x16x32_bf16 v[40:43], v[216:219], v[184:187], v[40:43]
    ds_read_b128 v[140:143], v228 offset:22528
    v_mfma_f32_16x16x32_bf16 v[48:51], v[208:211], v[188:191], v[48:51]
    ds_read_b128 v[144:147], v228 offset:24576
    v_mfma_f32_16x16x32_bf16 v[52:55], v[212:215], v[188:191], v[52:55]
    ds_read_b128 v[148:151], v228 offset:26624
    v_mfma_f32_16x16x32_bf16 v[60:63], v[220:223], v[188:191], v[60:63]
    ds_read_b128 v[152:155], v228 offset:28672
    v_mfma_f32_16x16x32_bf16 v[56:59], v[216:219], v[188:191], v[56:59]
    ds_read_b128 v[156:159], v228 offset:30720
    v_mfma_f32_16x16x32_bf16 v[64:67], v[208:211], v[192:195], v[64:67]
    v_mfma_f32_16x16x32_bf16 v[68:71], v[212:215], v[192:195], v[68:71]
    v_mfma_f32_16x16x32_bf16 v[76:79], v[220:223], v[192:195], v[76:79]
    v_mfma_f32_16x16x32_bf16 v[72:75], v[216:219], v[192:195], v[72:75]
    v_mfma_f32_16x16x32_bf16 v[80:83], v[208:211], v[196:199], v[80:83]
    v_mfma_f32_16x16x32_bf16 v[84:87], v[212:215], v[196:199], v[84:87]
    v_mfma_f32_16x16x32_bf16 v[92:95], v[220:223], v[196:199], v[92:95]
    v_mfma_f32_16x16x32_bf16 v[88:91], v[216:219], v[196:199], v[88:91]
    v_mfma_f32_16x16x32_bf16 v[96:99], v[208:211], v[200:203], v[96:99]
    v_mfma_f32_16x16x32_bf16 v[100:103], v[212:215], v[200:203], v[100:103]
    v_mfma_f32_16x16x32_bf16 v[108:111], v[220:223], v[200:203], v[108:111]
    v_mfma_f32_16x16x32_bf16 v[104:107], v[216:219], v[200:203], v[104:107]
    v_mfma_f32_16x16x32_bf16 v[112:115], v[208:211], v[204:207], v[112:115]
    v_mfma_f32_16x16x32_bf16 v[116:119], v[212:215], v[204:207], v[116:119]
    v_mfma_f32_16x16x32_bf16 v[124:127], v[220:223], v[204:207], v[124:127]
    v_mfma_f32_16x16x32_bf16 v[120:123], v[216:219], v[204:207], v[120:123]
    s_waitcnt lgkmcnt(0)
    s_barrier
    v_mfma_f32_16x16x32_bf16 v[0:3], v[160:163], v[128:131], v[0:3]
    ds_read_b64_tr_b16 v[208:209], v232 offset:16384
    v_mfma_f32_16x16x32_bf16 v[4:7], v[164:167], v[128:131], v[4:7]
    ds_read_b64_tr_b16 v[210:211], v232 offset:17408
    v_mfma_f32_16x16x32_bf16 v[12:15], v[172:175], v[128:131], v[12:15]
    ds_read_b64_tr_b16 v[212:213], v233 offset:16384
    v_mfma_f32_16x16x32_bf16 v[8:11], v[168:171], v[128:131], v[8:11]
    ds_read_b64_tr_b16 v[214:215], v233 offset:17408
    v_mfma_f32_16x16x32_bf16 v[16:19], v[160:163], v[132:135], v[16:19]
    ds_read_b64_tr_b16 v[216:217], v232 offset:24576
    v_mfma_f32_16x16x32_bf16 v[20:23], v[164:167], v[132:135], v[20:23]
    ds_read_b64_tr_b16 v[218:219], v232 offset:25600
    v_mfma_f32_16x16x32_bf16 v[28:31], v[172:175], v[132:135], v[28:31]
    ds_read_b64_tr_b16 v[220:221], v233 offset:24576
    v_mfma_f32_16x16x32_bf16 v[24:27], v[168:171], v[132:135], v[24:27]
    ds_read_b64_tr_b16 v[222:223], v233 offset:25600
    v_mfma_f32_16x16x32_bf16 v[32:35], v[160:163], v[136:139], v[32:35]
    ds_read_b128 v[176:179], v229 offset:16384
    v_mfma_f32_16x16x32_bf16 v[36:39], v[164:167], v[136:139], v[36:39]
    ds_read_b128 v[180:183], v229 offset:18432
    v_mfma_f32_16x16x32_bf16 v[44:47], v[172:175], v[136:139], v[44:47]
    ds_read_b128 v[184:187], v229 offset:20480
    v_mfma_f32_16x16x32_bf16 v[40:43], v[168:171], v[136:139], v[40:43]
    ds_read_b128 v[188:191], v229 offset:22528
    v_mfma_f32_16x16x32_bf16 v[48:51], v[160:163], v[140:143], v[48:51]
    ds_read_b128 v[192:195], v229 offset:24576
    v_mfma_f32_16x16x32_bf16 v[52:55], v[164:167], v[140:143], v[52:55]
    ds_read_b128 v[196:199], v229 offset:26624
    v_mfma_f32_16x16x32_bf16 v[60:63], v[172:175], v[140:143], v[60:63]
    ds_read_b128 v[200:203], v229 offset:28672
    v_mfma_f32_16x16x32_bf16 v[56:59], v[168:171], v[140:143], v[56:59]
    ds_read_b128 v[204:207], v229 offset:30720
    v_mfma_f32_16x16x32_bf16 v[64:67], v[160:163], v[144:147], v[64:67]
    v_mfma_f32_16x16x32_bf16 v[68:71], v[164:167], v[144:147], v[68:71]
    v_mfma_f32_16x16x32_bf16 v[76:79], v[172:175], v[144:147], v[76:79]
    v_mfma_f32_16x16x32_bf16 v[72:75], v[168:171], v[144:147], v[72:75]
    v_mfma_f32_16x16x32_bf16 v[80:83], v[160:163], v[148:151], v[80:83]
    v_mfma_f32_16x16x32_bf16 v[84:87], v[164:167], v[148:151], v[84:87]
    v_mfma_f32_16x16x32_bf16 v[92:95], v[172:175], v[148:151], v[92:95]
    v_mfma_f32_16x16x32_bf16 v[88:91], v[168:171], v[148:151], v[88:91]
    v_mfma_f32_16x16x32_bf16 v[96:99], v[160:163], v[152:155], v[96:99]
    v_mfma_f32_16x16x32_bf16 v[100:103], v[164:167], v[152:155], v[100:103]
    v_mfma_f32_16x16x32_bf16 v[108:111], v[172:175], v[152:155], v[108:111]
    v_mfma_f32_16x16x32_bf16 v[104:107], v[168:171], v[152:155], v[104:107]
    v_mfma_f32_16x16x32_bf16 v[112:115], v[160:163], v[156:159], v[112:115]
    v_mfma_f32_16x16x32_bf16 v[116:119], v[164:167], v[156:159], v[116:119]
    v_mfma_f32_16x16x32_bf16 v[124:127], v[172:175], v[156:159], v[124:127]
    v_mfma_f32_16x16x32_bf16 v[120:123], v[168:171], v[156:159], v[120:123]
    s_waitcnt lgkmcnt(0)
    s_barrier
    v_mfma_f32_16x16x32_bf16 v[0:3], v[208:211], v[176:179], v[0:3]
    v_mfma_f32_16x16x32_bf16 v[4:7], v[212:215], v[176:179], v[4:7]
    v_mfma_f32_16x16x32_bf16 v[12:15], v[220:223], v[176:179], v[12:15]
    v_mfma_f32_16x16x32_bf16 v[8:11], v[216:219], v[176:179], v[8:11]
    v_mfma_f32_16x16x32_bf16 v[16:19], v[208:211], v[180:183], v[16:19]
    v_mfma_f32_16x16x32_bf16 v[20:23], v[212:215], v[180:183], v[20:23]
    v_mfma_f32_16x16x32_bf16 v[28:31], v[220:223], v[180:183], v[28:31]
    v_mfma_f32_16x16x32_bf16 v[24:27], v[216:219], v[180:183], v[24:27]
    v_mfma_f32_16x16x32_bf16 v[32:35], v[208:211], v[184:187], v[32:35]
    v_mfma_f32_16x16x32_bf16 v[36:39], v[212:215], v[184:187], v[36:39]
    v_mfma_f32_16x16x32_bf16 v[44:47], v[220:223], v[184:187], v[44:47]
    v_mfma_f32_16x16x32_bf16 v[40:43], v[216:219], v[184:187], v[40:43]
    v_mfma_f32_16x16x32_bf16 v[48:51], v[208:211], v[188:191], v[48:51]
    v_mfma_f32_16x16x32_bf16 v[52:55], v[212:215], v[188:191], v[52:55]
    v_mfma_f32_16x16x32_bf16 v[60:63], v[220:223], v[188:191], v[60:63]
    v_mfma_f32_16x16x32_bf16 v[56:59], v[216:219], v[188:191], v[56:59]
    v_mfma_f32_16x16x32_bf16 v[64:67], v[208:211], v[192:195], v[64:67]
    v_mfma_f32_16x16x32_bf16 v[68:71], v[212:215], v[192:195], v[68:71]
    v_mfma_f32_16x16x32_bf16 v[76:79], v[220:223], v[192:195], v[76:79]
    v_mfma_f32_16x16x32_bf16 v[72:75], v[216:219], v[192:195], v[72:75]
    v_mfma_f32_16x16x32_bf16 v[80:83], v[208:211], v[196:199], v[80:83]
    v_mfma_f32_16x16x32_bf16 v[84:87], v[212:215], v[196:199], v[84:87]
    v_mfma_f32_16x16x32_bf16 v[92:95], v[220:223], v[196:199], v[92:95]
    v_mfma_f32_16x16x32_bf16 v[88:91], v[216:219], v[196:199], v[88:91]
    v_mfma_f32_16x16x32_bf16 v[96:99], v[208:211], v[200:203], v[96:99]
    v_mfma_f32_16x16x32_bf16 v[100:103], v[212:215], v[200:203], v[100:103]
    v_mfma_f32_16x16x32_bf16 v[108:111], v[220:223], v[200:203], v[108:111]
    v_mfma_f32_16x16x32_bf16 v[104:107], v[216:219], v[200:203], v[104:107]
    v_mfma_f32_16x16x32_bf16 v[112:115], v[208:211], v[204:207], v[112:115]
    v_mfma_f32_16x16x32_bf16 v[116:119], v[212:215], v[204:207], v[116:119]
    v_mfma_f32_16x16x32_bf16 v[124:127], v[220:223], v[204:207], v[124:127]
    v_mfma_f32_16x16x32_bf16 v[120:123], v[216:219], v[204:207], v[120:123]
    s_mov_b32 s60, 0xbfb8aa3b
    s_mov_b32 s61, 0xbfb8aa3b
    s_nop 7
    v_pk_mul_f32 v[128:129], v[0:1], s[60:61]
    v_pk_mul_f32 v[130:131], v[2:3], s[60:61]
    v_pk_mul_f32 v[132:133], v[4:5], s[60:61]
    v_pk_mul_f32 v[134:135], v[6:7], s[60:61]
    v_exp_f32 v128, v128
    v_exp_f32 v129, v129
    v_exp_f32 v130, v130
    v_exp_f32 v131, v131
    v_exp_f32 v132, v132
    v_exp_f32 v133, v133
    v_exp_f32 v134, v134
    v_exp_f32 v135, v135
    v_pk_mul_f32 v[0:1], v[0:1], v[8:9]
    v_pk_mul_f32 v[2:3], v[2:3], v[10:11]
    v_pk_mul_f32 v[4:5], v[4:5], v[12:13]
    v_pk_mul_f32 v[6:7], v[6:7], v[14:15]
    v_pk_add_f32 v[128:129], v[128:129], 1.0 op_sel_hi:[1,0]
    v_pk_add_f32 v[130:131], v[130:131], 1.0 op_sel_hi:[1,0]
    v_pk_add_f32 v[132:133], v[132:133], 1.0 op_sel_hi:[1,0]
    v_pk_add_f32 v[134:135], v[134:135], 1.0 op_sel_hi:[1,0]
    v_rcp_f32 v128, v128
    v_rcp_f32 v129, v129
    v_rcp_f32 v130, v130
    v_rcp_f32 v131, v131
    v_rcp_f32 v132, v132
    v_rcp_f32 v133, v133
    v_rcp_f32 v134, v134
    v_rcp_f32 v135, v135
    s_add_u32 s29, s28, 0
    v_pk_mul_f32 v[0:1], v[0:1], v[128:129]
    v_pk_mul_f32 v[2:3], v[2:3], v[130:131]
    v_pk_mul_f32 v[4:5], v[4:5], v[132:133]
    v_pk_mul_f32 v[6:7], v[6:7], v[134:135]
    v_cvt_pk_bf16_f32 v136, v0, v1
    v_cvt_pk_bf16_f32 v137, v2, v3
    v_cvt_pk_bf16_f32 v138, v4, v5
    v_cvt_pk_bf16_f32 v139, v6, v7
    buffer_store_dwordx4 v[136:139], v244, s[52:55], s29 offen sc1
    v_pk_mul_f32 v[144:145], v[16:17], s[60:61]
    v_pk_mul_f32 v[146:147], v[18:19], s[60:61]
    v_pk_mul_f32 v[148:149], v[20:21], s[60:61]
    v_pk_mul_f32 v[150:151], v[22:23], s[60:61]
    v_exp_f32 v144, v144
    v_exp_f32 v145, v145
    v_exp_f32 v146, v146
    v_exp_f32 v147, v147
    v_exp_f32 v148, v148
    v_exp_f32 v149, v149
    v_exp_f32 v150, v150
    v_exp_f32 v151, v151
    v_pk_mul_f32 v[16:17], v[16:17], v[24:25]
    v_pk_mul_f32 v[18:19], v[18:19], v[26:27]
    v_pk_mul_f32 v[20:21], v[20:21], v[28:29]
    v_pk_mul_f32 v[22:23], v[22:23], v[30:31]
    v_pk_add_f32 v[144:145], v[144:145], 1.0 op_sel_hi:[1,0]
    v_pk_add_f32 v[146:147], v[146:147], 1.0 op_sel_hi:[1,0]
    v_pk_add_f32 v[148:149], v[148:149], 1.0 op_sel_hi:[1,0]
    v_pk_add_f32 v[150:151], v[150:151], 1.0 op_sel_hi:[1,0]
    v_rcp_f32 v144, v144
    v_rcp_f32 v145, v145
    v_rcp_f32 v146, v146
    v_rcp_f32 v147, v147
    v_rcp_f32 v148, v148
    v_rcp_f32 v149, v149
    v_rcp_f32 v150, v150
    v_rcp_f32 v151, v151
    s_add_u32 s29, s28, 917504
    v_pk_mul_f32 v[16:17], v[16:17], v[144:145]
    v_pk_mul_f32 v[18:19], v[18:19], v[146:147]
    v_pk_mul_f32 v[20:21], v[20:21], v[148:149]
    v_pk_mul_f32 v[22:23], v[22:23], v[150:151]
    v_cvt_pk_bf16_f32 v152, v16, v17
    v_cvt_pk_bf16_f32 v153, v18, v19
    v_cvt_pk_bf16_f32 v154, v20, v21
    v_cvt_pk_bf16_f32 v155, v22, v23
    buffer_store_dwordx4 v[152:155], v244, s[52:55], s29 offen sc1
    v_pk_mul_f32 v[128:129], v[32:33], s[60:61]
    v_pk_mul_f32 v[130:131], v[34:35], s[60:61]
    v_pk_mul_f32 v[132:133], v[36:37], s[60:61]
    v_pk_mul_f32 v[134:135], v[38:39], s[60:61]
    v_exp_f32 v128, v128
    v_exp_f32 v129, v129
    v_exp_f32 v130, v130
    v_exp_f32 v131, v131
    v_exp_f32 v132, v132
    v_exp_f32 v133, v133
    v_exp_f32 v134, v134
    v_exp_f32 v135, v135
    v_pk_mul_f32 v[32:33], v[32:33], v[40:41]
    v_pk_mul_f32 v[34:35], v[34:35], v[42:43]
    v_pk_mul_f32 v[36:37], v[36:37], v[44:45]
    v_pk_mul_f32 v[38:39], v[38:39], v[46:47]
    v_pk_add_f32 v[128:129], v[128:129], 1.0 op_sel_hi:[1,0]
    v_pk_add_f32 v[130:131], v[130:131], 1.0 op_sel_hi:[1,0]
    v_pk_add_f32 v[132:133], v[132:133], 1.0 op_sel_hi:[1,0]
    v_pk_add_f32 v[134:135], v[134:135], 1.0 op_sel_hi:[1,0]
    v_rcp_f32 v128, v128
    v_rcp_f32 v129, v129
    v_rcp_f32 v130, v130
    v_rcp_f32 v131, v131
    v_rcp_f32 v132, v132
    v_rcp_f32 v133, v133
    v_rcp_f32 v134, v134
    v_rcp_f32 v135, v135
    s_add_u32 s29, s28, 1835008
    v_pk_mul_f32 v[32:33], v[32:33], v[128:129]
    v_pk_mul_f32 v[34:35], v[34:35], v[130:131]
    v_pk_mul_f32 v[36:37], v[36:37], v[132:133]
    v_pk_mul_f32 v[38:39], v[38:39], v[134:135]
    v_cvt_pk_bf16_f32 v136, v32, v33
    v_cvt_pk_bf16_f32 v137, v34, v35
    v_cvt_pk_bf16_f32 v138, v36, v37
    v_cvt_pk_bf16_f32 v139, v38, v39
    buffer_store_dwordx4 v[136:139], v244, s[52:55], s29 offen sc1
    v_pk_mul_f32 v[144:145], v[48:49], s[60:61]
    v_pk_mul_f32 v[146:147], v[50:51], s[60:61]
    v_pk_mul_f32 v[148:149], v[52:53], s[60:61]
    v_pk_mul_f32 v[150:151], v[54:55], s[60:61]
    v_exp_f32 v144, v144
    v_exp_f32 v145, v145
    v_exp_f32 v146, v146
    v_exp_f32 v147, v147
    v_exp_f32 v148, v148
    v_exp_f32 v149, v149
    v_exp_f32 v150, v150
    v_exp_f32 v151, v151
    v_pk_mul_f32 v[48:49], v[48:49], v[56:57]
    v_pk_mul_f32 v[50:51], v[50:51], v[58:59]
    v_pk_mul_f32 v[52:53], v[52:53], v[60:61]
    v_pk_mul_f32 v[54:55], v[54:55], v[62:63]
    v_pk_add_f32 v[144:145], v[144:145], 1.0 op_sel_hi:[1,0]
    v_pk_add_f32 v[146:147], v[146:147], 1.0 op_sel_hi:[1,0]
    v_pk_add_f32 v[148:149], v[148:149], 1.0 op_sel_hi:[1,0]
    v_pk_add_f32 v[150:151], v[150:151], 1.0 op_sel_hi:[1,0]
    v_rcp_f32 v144, v144
    v_rcp_f32 v145, v145
    v_rcp_f32 v146, v146
    v_rcp_f32 v147, v147
    v_rcp_f32 v148, v148
    v_rcp_f32 v149, v149
    v_rcp_f32 v150, v150
    v_rcp_f32 v151, v151
    s_add_u32 s29, s28, 2752512
    v_pk_mul_f32 v[48:49], v[48:49], v[144:145]
    v_pk_mul_f32 v[50:51], v[50:51], v[146:147]
    v_pk_mul_f32 v[52:53], v[52:53], v[148:149]
    v_pk_mul_f32 v[54:55], v[54:55], v[150:151]
    v_cvt_pk_bf16_f32 v152, v48, v49
    v_cvt_pk_bf16_f32 v153, v50, v51
    v_cvt_pk_bf16_f32 v154, v52, v53
    v_cvt_pk_bf16_f32 v155, v54, v55
    buffer_store_dwordx4 v[152:155], v244, s[52:55], s29 offen sc1
    v_pk_mul_f32 v[128:129], v[64:65], s[60:61]
    v_pk_mul_f32 v[130:131], v[66:67], s[60:61]
    v_pk_mul_f32 v[132:133], v[68:69], s[60:61]
    v_pk_mul_f32 v[134:135], v[70:71], s[60:61]
    v_exp_f32 v128, v128
    v_exp_f32 v129, v129
    v_exp_f32 v130, v130
    v_exp_f32 v131, v131
    v_exp_f32 v132, v132
    v_exp_f32 v133, v133
    v_exp_f32 v134, v134
    v_exp_f32 v135, v135
    v_pk_mul_f32 v[64:65], v[64:65], v[72:73]
    v_pk_mul_f32 v[66:67], v[66:67], v[74:75]
    v_pk_mul_f32 v[68:69], v[68:69], v[76:77]
    v_pk_mul_f32 v[70:71], v[70:71], v[78:79]
    v_pk_add_f32 v[128:129], v[128:129], 1.0 op_sel_hi:[1,0]
    v_pk_add_f32 v[130:131], v[130:131], 1.0 op_sel_hi:[1,0]
    v_pk_add_f32 v[132:133], v[132:133], 1.0 op_sel_hi:[1,0]
    v_pk_add_f32 v[134:135], v[134:135], 1.0 op_sel_hi:[1,0]
    v_rcp_f32 v128, v128
    v_rcp_f32 v129, v129
    v_rcp_f32 v130, v130
    v_rcp_f32 v131, v131
    v_rcp_f32 v132, v132
    v_rcp_f32 v133, v133
    v_rcp_f32 v134, v134
    v_rcp_f32 v135, v135
    s_add_u32 s29, s28, 3670016
    v_pk_mul_f32 v[64:65], v[64:65], v[128:129]
    v_pk_mul_f32 v[66:67], v[66:67], v[130:131]
    v_pk_mul_f32 v[68:69], v[68:69], v[132:133]
    v_pk_mul_f32 v[70:71], v[70:71], v[134:135]
    v_cvt_pk_bf16_f32 v136, v64, v65
    v_cvt_pk_bf16_f32 v137, v66, v67
    v_cvt_pk_bf16_f32 v138, v68, v69
    v_cvt_pk_bf16_f32 v139, v70, v71
    buffer_store_dwordx4 v[136:139], v244, s[52:55], s29 offen sc1
    v_pk_mul_f32 v[144:145], v[80:81], s[60:61]
    v_pk_mul_f32 v[146:147], v[82:83], s[60:61]
    v_pk_mul_f32 v[148:149], v[84:85], s[60:61]
    v_pk_mul_f32 v[150:151], v[86:87], s[60:61]
    v_exp_f32 v144, v144
    v_exp_f32 v145, v145
    v_exp_f32 v146, v146
    v_exp_f32 v147, v147
    v_exp_f32 v148, v148
    v_exp_f32 v149, v149
    v_exp_f32 v150, v150
    v_exp_f32 v151, v151
    v_pk_mul_f32 v[80:81], v[80:81], v[88:89]
    v_pk_mul_f32 v[82:83], v[82:83], v[90:91]
    v_pk_mul_f32 v[84:85], v[84:85], v[92:93]
    v_pk_mul_f32 v[86:87], v[86:87], v[94:95]
    v_pk_add_f32 v[144:145], v[144:145], 1.0 op_sel_hi:[1,0]
    v_pk_add_f32 v[146:147], v[146:147], 1.0 op_sel_hi:[1,0]
    v_pk_add_f32 v[148:149], v[148:149], 1.0 op_sel_hi:[1,0]
    v_pk_add_f32 v[150:151], v[150:151], 1.0 op_sel_hi:[1,0]
    v_rcp_f32 v144, v144
    v_rcp_f32 v145, v145
    v_rcp_f32 v146, v146
    v_rcp_f32 v147, v147
    v_rcp_f32 v148, v148
    v_rcp_f32 v149, v149
    v_rcp_f32 v150, v150
    v_rcp_f32 v151, v151
    s_add_u32 s29, s28, 4587520
    v_pk_mul_f32 v[80:81], v[80:81], v[144:145]
    v_pk_mul_f32 v[82:83], v[82:83], v[146:147]
    v_pk_mul_f32 v[84:85], v[84:85], v[148:149]
    v_pk_mul_f32 v[86:87], v[86:87], v[150:151]
    v_cvt_pk_bf16_f32 v152, v80, v81
    v_cvt_pk_bf16_f32 v153, v82, v83
    v_cvt_pk_bf16_f32 v154, v84, v85
    v_cvt_pk_bf16_f32 v155, v86, v87
    buffer_store_dwordx4 v[152:155], v244, s[52:55], s29 offen sc1
    v_pk_mul_f32 v[128:129], v[96:97], s[60:61]
    v_pk_mul_f32 v[130:131], v[98:99], s[60:61]
    v_pk_mul_f32 v[132:133], v[100:101], s[60:61]
    v_pk_mul_f32 v[134:135], v[102:103], s[60:61]
    v_exp_f32 v128, v128
    v_exp_f32 v129, v129
    v_exp_f32 v130, v130
    v_exp_f32 v131, v131
    v_exp_f32 v132, v132
    v_exp_f32 v133, v133
    v_exp_f32 v134, v134
    v_exp_f32 v135, v135
    v_pk_mul_f32 v[96:97], v[96:97], v[104:105]
    v_pk_mul_f32 v[98:99], v[98:99], v[106:107]
    v_pk_mul_f32 v[100:101], v[100:101], v[108:109]
    v_pk_mul_f32 v[102:103], v[102:103], v[110:111]
    v_pk_add_f32 v[128:129], v[128:129], 1.0 op_sel_hi:[1,0]
    v_pk_add_f32 v[130:131], v[130:131], 1.0 op_sel_hi:[1,0]
    v_pk_add_f32 v[132:133], v[132:133], 1.0 op_sel_hi:[1,0]
    v_pk_add_f32 v[134:135], v[134:135], 1.0 op_sel_hi:[1,0]
    v_rcp_f32 v128, v128
    v_rcp_f32 v129, v129
    v_rcp_f32 v130, v130
    v_rcp_f32 v131, v131
    v_rcp_f32 v132, v132
    v_rcp_f32 v133, v133
    v_rcp_f32 v134, v134
    v_rcp_f32 v135, v135
    s_add_u32 s29, s28, 5505024
    v_pk_mul_f32 v[96:97], v[96:97], v[128:129]
    v_pk_mul_f32 v[98:99], v[98:99], v[130:131]
    v_pk_mul_f32 v[100:101], v[100:101], v[132:133]
    v_pk_mul_f32 v[102:103], v[102:103], v[134:135]
    v_cvt_pk_bf16_f32 v136, v96, v97
    v_cvt_pk_bf16_f32 v137, v98, v99
    v_cvt_pk_bf16_f32 v138, v100, v101
    v_cvt_pk_bf16_f32 v139, v102, v103
    buffer_store_dwordx4 v[136:139], v244, s[52:55], s29 offen sc1
    v_pk_mul_f32 v[144:145], v[112:113], s[60:61]
    v_pk_mul_f32 v[146:147], v[114:115], s[60:61]
    v_pk_mul_f32 v[148:149], v[116:117], s[60:61]
    v_pk_mul_f32 v[150:151], v[118:119], s[60:61]
    v_exp_f32 v144, v144
    v_exp_f32 v145, v145
    v_exp_f32 v146, v146
    v_exp_f32 v147, v147
    v_exp_f32 v148, v148
    v_exp_f32 v149, v149
    v_exp_f32 v150, v150
    v_exp_f32 v151, v151
    v_pk_mul_f32 v[112:113], v[112:113], v[120:121]
    v_pk_mul_f32 v[114:115], v[114:115], v[122:123]
    v_pk_mul_f32 v[116:117], v[116:117], v[124:125]
    v_pk_mul_f32 v[118:119], v[118:119], v[126:127]
    v_pk_add_f32 v[144:145], v[144:145], 1.0 op_sel_hi:[1,0]
    v_pk_add_f32 v[146:147], v[146:147], 1.0 op_sel_hi:[1,0]
    v_pk_add_f32 v[148:149], v[148:149], 1.0 op_sel_hi:[1,0]
    v_pk_add_f32 v[150:151], v[150:151], 1.0 op_sel_hi:[1,0]
    v_rcp_f32 v144, v144
    v_rcp_f32 v145, v145
    v_rcp_f32 v146, v146
    v_rcp_f32 v147, v147
    v_rcp_f32 v148, v148
    v_rcp_f32 v149, v149
    v_rcp_f32 v150, v150
    v_rcp_f32 v151, v151
    s_add_u32 s29, s28, 6422528
    v_pk_mul_f32 v[112:113], v[112:113], v[144:145]
    v_pk_mul_f32 v[114:115], v[114:115], v[146:147]
    v_pk_mul_f32 v[116:117], v[116:117], v[148:149]
    v_pk_mul_f32 v[118:119], v[118:119], v[150:151]
    v_cvt_pk_bf16_f32 v152, v112, v113
    v_cvt_pk_bf16_f32 v153, v114, v115
    v_cvt_pk_bf16_f32 v154, v116, v117
    v_cvt_pk_bf16_f32 v155, v118, v119
    buffer_store_dwordx4 v[152:155], v244, s[52:55], s29 offen sc1
    s_branch c2
.p2align 6
k1_dft_c:
    s_mov_b32 s52, s22
    s_and_b32 s53, s23, 0xffff
    s_mov_b32 s54, 0xa04000
    s_mov_b32 s55, 0x20000
    s_mov_b32 s36, s22
    s_and_b32 s37, s23, 0xffff
    s_mov_b32 s38, 0xa04000
    s_mov_b32 s39, 0x20000
    s_mov_b32 s48, s64
    s_and_b32 s49, s65, 0xffff
    s_mov_b32 s50, 0x200000
    s_mov_b32 s51, 0x20000
    v_and_b32 v236, 63, v0
    v_and_b32 v237, 15, v236
    v_lshrrev_b32 v238, 4, v236
    v_lshrrev_b32 v239, 1, v237
    v_xor_b32 v239, v239, v238
    v_lshlrev_b32 v239, 4, v239
    v_lshl_add_u32 v224, v237, 7, v239
    v_xor_b32 v225, 64, v224
    v_lshrrev_b32 v239, 2, v237
    v_and_b32 v240, 1, v238
    v_lshl_or_b32 v240, v240, 2, v239
    s_lshl_b32 s26, s3, 1
    v_xor_b32 v240, s26, v240
    v_lshlrev_b32 v240, 5, v240
    v_lshl_add_u32 v241, v238, 3, v239
    v_lshl_add_u32 v240, v241, 8, v240
    v_and_b32 v241, 3, v237
    v_lshl_add_u32 v230, v241, 3, v240
    v_xor_b32 v231, 32, v230
    v_add_u32 v226, 0x10000, v224
    v_add_u32 v227, 0x10000, v225
    v_add_u32 v232, 0x10000, v230
    v_add_u32 v233, 0x10000, v231
    v_add_u32 v228, 0x20000, v224
    v_add_u32 v229, 0x20000, v225
    v_add_u32 v234, 0x20000, v230
    v_add_u32 v235, 0x20000, v231
    v_xor_b32 v239, v237, v238
    v_lshlrev_b32 v239, 4, v239
    v_lshl_add_u32 v242, v237, 8, v239
    v_mov_b32 v243, 0xbf803f80
    v_cmp_eq_u32 s[62:63], 0, v237
    s_or_b32 s26, s3, s25
    s_cmp_eq_u32 s26, 0
    s_cselect_b64 s[60:61], s[62:63], 0
    s_lshl_b32 s26, s3, 5
    v_add_u32 v239, s26, v237
    v_lshlrev_b32 v239, 4, v239
    v_lshl_add_u32 v244, v238, 17, v239
    s_lshl_b32 s26, s24, 12
    s_lshl_b32 s27, s25, 11
    s_add_u32 s28, s26, s27
    s_add_u32 s28, s28, 8388608
    s_cmp_lt_u32 s3, 2
    s_cselect_b32 s34, s6, s8
    s_cselect_b32 s35, s7, s9
    s_mov_b32 s32, s34
    s_and_b32 s33, s35, 0xffff
    s_mov_b32 s34, 0x800000
    s_mov_b32 s35, 0x20000
    s_and_b32 s26, s3, 1
    s_lshl_b32 s26, s26, 7
    v_lshlrev_b32 v252, 16, v236
    buffer_load_dword v253, v252, s[32:35], s26 offen
    s_barrier
    ds_read_b64_tr_b16 v[160:161], v230 offset:16384
    ds_read_b64_tr_b16 v[162:163], v230 offset:17408
    ds_read_b64_tr_b16 v[164:165], v231 offset:16384
    ds_read_b64_tr_b16 v[166:167], v231 offset:17408
    ds_read_b64_tr_b16 v[168:169], v230 offset:24576
    ds_read_b64_tr_b16 v[170:171], v230 offset:25600
    ds_read_b64_tr_b16 v[172:173], v231 offset:24576
    ds_read_b64_tr_b16 v[174:175], v231 offset:25600
    ds_read_b128 v[128:131], v224 offset:0
    ds_read_b128 v[132:135], v224 offset:2048
    ds_read_b128 v[136:139], v224 offset:4096
    ds_read_b128 v[140:143], v224 offset:6144
    ds_read_b128 v[144:147], v224 offset:8192
    ds_read_b128 v[148:151], v224 offset:10240
    ds_read_b128 v[152:155], v224 offset:12288
    ds_read_b128 v[156:159], v224 offset:14336
    s_waitcnt lgkmcnt(0)
    s_barrier
    v_cndmask_b32 v168, v168, v243, s[60:61]
    v_cndmask_b32 v169, v169, v243, s[60:61]
    v_cndmask_b32 v170, v170, v243, s[60:61]
    v_cndmask_b32 v171, v171, v243, s[60:61]
    v_mfma_f32_16x16x32_bf16 v[0:3], v[128:131], v[160:163], 0
    ds_read_b64_tr_b16 v[208:209], v230 offset:32768
    v_mfma_f32_16x16x32_bf16 v[4:7], v[128:131], v[164:167], 0
    ds_read_b64_tr_b16 v[210:211], v230 offset:33792
    v_mfma_f32_16x16x32_bf16 v[12:15], v[128:131], v[172:175], 0
    ds_read_b64_tr_b16 v[212:213], v231 offset:32768
    v_mfma_f32_16x16x32_bf16 v[8:11], v[128:131], v[168:171], 0
    ds_read_b64_tr_b16 v[214:215], v231 offset:33792
    v_mfma_f32_16x16x32_bf16 v[16:19], v[132:135], v[160:163], 0
    ds_read_b64_tr_b16 v[216:217], v230 offset:40960
    v_mfma_f32_16x16x32_bf16 v[20:23], v[132:135], v[164:167], 0
    ds_read_b64_tr_b16 v[218:219], v230 offset:41984
    v_mfma_f32_16x16x32_bf16 v[28:31], v[132:135], v[172:175], 0
    ds_read_b64_tr_b16 v[220:221], v231 offset:40960
    v_mfma_f32_16x16x32_bf16 v[24:27], v[132:135], v[168:171], 0
    ds_read_b64_tr_b16 v[222:223], v231 offset:41984
    v_mfma_f32_16x16x32_bf16 v[32:35], v[136:139], v[160:163], 0
    ds_read_b128 v[176:179], v225 offset:0
    v_mfma_f32_16x16x32_bf16 v[36:39], v[136:139], v[164:167], 0
    ds_read_b128 v[180:183], v225 offset:2048
    v_mfma_f32_16x16x32_bf16 v[44:47], v[136:139], v[172:175], 0
    ds_read_b128 v[184:187], v225 offset:4096
    v_mfma_f32_16x16x32_bf16 v[40:43], v[136:139], v[168:171], 0
    ds_read_b128 v[188:191], v225 offset:6144
    v_mfma_f32_16x16x32_bf16 v[48:51], v[140:143], v[160:163], 0
    ds_read_b128 v[192:195], v225 offset:8192
    v_mfma_f32_16x16x32_bf16 v[52:55], v[140:143], v[164:167], 0
    ds_read_b128 v[196:199], v225 offset:10240
    v_mfma_f32_16x16x32_bf16 v[60:63], v[140:143], v[172:175], 0
    ds_read_b128 v[200:203], v225 offset:12288
    v_mfma_f32_16x16x32_bf16 v[56:59], v[140:143], v[168:171], 0
    ds_read_b128 v[204:207], v225 offset:14336
    v_mfma_f32_16x16x32_bf16 v[64:67], v[144:147], v[160:163], 0
    v_mfma_f32_16x16x32_bf16 v[68:71], v[144:147], v[164:167], 0
    v_mfma_f32_16x16x32_bf16 v[76:79], v[144:147], v[172:175], 0
    v_mfma_f32_16x16x32_bf16 v[72:75], v[144:147], v[168:171], 0
    v_mfma_f32_16x16x32_bf16 v[80:83], v[148:151], v[160:163], 0
    v_mfma_f32_16x16x32_bf16 v[84:87], v[148:151], v[164:167], 0
    v_mfma_f32_16x16x32_bf16 v[92:95], v[148:151], v[172:175], 0
    v_mfma_f32_16x16x32_bf16 v[88:91], v[148:151], v[168:171], 0
    v_mfma_f32_16x16x32_bf16 v[96:99], v[152:155], v[160:163], 0
    v_mfma_f32_16x16x32_bf16 v[100:103], v[152:155], v[164:167], 0
    v_mfma_f32_16x16x32_bf16 v[108:111], v[152:155], v[172:175], 0
    v_mfma_f32_16x16x32_bf16 v[104:107], v[152:155], v[168:171], 0
    v_mfma_f32_16x16x32_bf16 v[112:115], v[156:159], v[160:163], 0
    v_mfma_f32_16x16x32_bf16 v[116:119], v[156:159], v[164:167], 0
    v_mfma_f32_16x16x32_bf16 v[124:127], v[156:159], v[172:175], 0
    v_mfma_f32_16x16x32_bf16 v[120:123], v[156:159], v[168:171], 0
    s_waitcnt lgkmcnt(0)
    s_barrier
    v_cndmask_b32 v216, v216, v243, s[60:61]
    v_cndmask_b32 v217, v217, v243, s[60:61]
    v_cndmask_b32 v218, v218, v243, s[60:61]
    v_cndmask_b32 v219, v219, v243, s[60:61]
    v_mfma_f32_16x16x32_bf16 v[0:3], v[176:179], v[208:211], v[0:3]
    ds_read_b64_tr_b16 v[160:161], v232 offset:0
    v_mfma_f32_16x16x32_bf16 v[4:7], v[176:179], v[212:215], v[4:7]
    ds_read_b64_tr_b16 v[162:163], v232 offset:1024
    v_mfma_f32_16x16x32_bf16 v[12:15], v[176:179], v[220:223], v[12:15]
    ds_read_b64_tr_b16 v[164:165], v233 offset:0
    v_mfma_f32_16x16x32_bf16 v[8:11], v[176:179], v[216:219], v[8:11]
    ds_read_b64_tr_b16 v[166:167], v233 offset:1024
    v_mfma_f32_16x16x32_bf16 v[16:19], v[180:183], v[208:211], v[16:19]
    ds_read_b64_tr_b16 v[168:169], v232 offset:8192
    v_mfma_f32_16x16x32_bf16 v[20:23], v[180:183], v[212:215], v[20:23]
    ds_read_b64_tr_b16 v[170:171], v232 offset:9216
    v_mfma_f32_16x16x32_bf16 v[28:31], v[180:183], v[220:223], v[28:31]
    ds_read_b64_tr_b16 v[172:173], v233 offset:8192
    v_mfma_f32_16x16x32_bf16 v[24:27], v[180:183], v[216:219], v[24:27]
    ds_read_b64_tr_b16 v[174:175], v233 offset:9216
    v_mfma_f32_16x16x32_bf16 v[32:35], v[184:187], v[208:211], v[32:35]
    ds_read_b128 v[128:131], v224 offset:49152
    v_mfma_f32_16x16x32_bf16 v[36:39], v[184:187], v[212:215], v[36:39]
    ds_read_b128 v[132:135], v224 offset:51200
    v_mfma_f32_16x16x32_bf16 v[44:47], v[184:187], v[220:223], v[44:47]
    ds_read_b128 v[136:139], v224 offset:53248
    v_mfma_f32_16x16x32_bf16 v[40:43], v[184:187], v[216:219], v[40:43]
    ds_read_b128 v[140:143], v224 offset:55296
    v_mfma_f32_16x16x32_bf16 v[48:51], v[188:191], v[208:211], v[48:51]
    ds_read_b128 v[144:147], v224 offset:57344
    v_mfma_f32_16x16x32_bf16 v[52:55], v[188:191], v[212:215], v[52:55]
    ds_read_b128 v[148:151], v224 offset:59392
    v_mfma_f32_16x16x32_bf16 v[60:63], v[188:191], v[220:223], v[60:63]
    ds_read_b128 v[152:155], v224 offset:61440
    v_mfma_f32_16x16x32_bf16 v[56:59], v[188:191], v[216:219], v[56:59]
    ds_read_b128 v[156:159], v224 offset:63488
    v_mfma_f32_16x16x32_bf16 v[64:67], v[192:195], v[208:211], v[64:67]
    v_mfma_f32_16x16x32_bf16 v[68:71], v[192:195], v[212:215], v[68:71]
    v_mfma_f32_16x16x32_bf16 v[76:79], v[192:195], v[220:223], v[76:79]
    v_mfma_f32_16x16x32_bf16 v[72:75], v[192:195], v[216:219], v[72:75]
    v_mfma_f32_16x16x32_bf16 v[80:83], v[196:199], v[208:211], v[80:83]
    v_mfma_f32_16x16x32_bf16 v[84:87], v[196:199], v[212:215], v[84:87]
    v_mfma_f32_16x16x32_bf16 v[92:95], v[196:199], v[220:223], v[92:95]
    v_mfma_f32_16x16x32_bf16 v[88:91], v[196:199], v[216:219], v[88:91]
    v_mfma_f32_16x16x32_bf16 v[96:99], v[200:203], v[208:211], v[96:99]
    v_mfma_f32_16x16x32_bf16 v[100:103], v[200:203], v[212:215], v[100:103]
    v_mfma_f32_16x16x32_bf16 v[108:111], v[200:203], v[220:223], v[108:111]
    v_mfma_f32_16x16x32_bf16 v[104:107], v[200:203], v[216:219], v[104:107]
    v_mfma_f32_16x16x32_bf16 v[112:115], v[204:207], v[208:211], v[112:115]
    v_mfma_f32_16x16x32_bf16 v[116:119], v[204:207], v[212:215], v[116:119]
    v_mfma_f32_16x16x32_bf16 v[124:127], v[204:207], v[220:223], v[124:127]
    v_mfma_f32_16x16x32_bf16 v[120:123], v[204:207], v[216:219], v[120:123]
    s_waitcnt lgkmcnt(0)
    s_barrier
    v_cndmask_b32 v168, v168, v243, s[60:61]
    v_cndmask_b32 v169, v169, v243, s[60:61]
    v_cndmask_b32 v170, v170, v243, s[60:61]
    v_cndmask_b32 v171, v171, v243, s[60:61]
    v_mfma_f32_16x16x32_bf16 v[0:3], v[128:131], v[160:163], v[0:3]
    ds_read_b64_tr_b16 v[208:209], v232 offset:16384
    v_mfma_f32_16x16x32_bf16 v[4:7], v[128:131], v[164:167], v[4:7]
    ds_read_b64_tr_b16 v[210:211], v232 offset:17408
    v_mfma_f32_16x16x32_bf16 v[12:15], v[128:131], v[172:175], v[12:15]
    ds_read_b64_tr_b16 v[212:213], v233 offset:16384
    v_mfma_f32_16x16x32_bf16 v[8:11], v[128:131], v[168:171], v[8:11]
    ds_read_b64_tr_b16 v[214:215], v233 offset:17408
    v_mfma_f32_16x16x32_bf16 v[16:19], v[132:135], v[160:163], v[16:19]
    ds_read_b64_tr_b16 v[216:217], v232 offset:24576
    v_mfma_f32_16x16x32_bf16 v[20:23], v[132:135], v[164:167], v[20:23]
    ds_read_b64_tr_b16 v[218:219], v232 offset:25600
    v_mfma_f32_16x16x32_bf16 v[28:31], v[132:135], v[172:175], v[28:31]
    ds_read_b64_tr_b16 v[220:221], v233 offset:24576
    v_mfma_f32_16x16x32_bf16 v[24:27], v[132:135], v[168:171], v[24:27]
    ds_read_b64_tr_b16 v[222:223], v233 offset:25600
    v_mfma_f32_16x16x32_bf16 v[32:35], v[136:139], v[160:163], v[32:35]
    ds_read_b128 v[176:179], v225 offset:49152
    v_mfma_f32_16x16x32_bf16 v[36:39], v[136:139], v[164:167], v[36:39]
    ds_read_b128 v[180:183], v225 offset:51200
    v_mfma_f32_16x16x32_bf16 v[44:47], v[136:139], v[172:175], v[44:47]
    ds_read_b128 v[184:187], v225 offset:53248
    v_mfma_f32_16x16x32_bf16 v[40:43], v[136:139], v[168:171], v[40:43]
    ds_read_b128 v[188:191], v225 offset:55296
    v_mfma_f32_16x16x32_bf16 v[48:51], v[140:143], v[160:163], v[48:51]
    ds_read_b128 v[192:195], v225 offset:57344
    v_mfma_f32_16x16x32_bf16 v[52:55], v[140:143], v[164:167], v[52:55]
    ds_read_b128 v[196:199], v225 offset:59392
    v_mfma_f32_16x16x32_bf16 v[60:63], v[140:143], v[172:175], v[60:63]
    ds_read_b128 v[200:203], v225 offset:61440
    v_mfma_f32_16x16x32_bf16 v[56:59], v[140:143], v[168:171], v[56:59]
    ds_read_b128 v[204:207], v225 offset:63488
    v_mfma_f32_16x16x32_bf16 v[64:67], v[144:147], v[160:163], v[64:67]
    v_mfma_f32_16x16x32_bf16 v[68:71], v[144:147], v[164:167], v[68:71]
    v_mfma_f32_16x16x32_bf16 v[76:79], v[144:147], v[172:175], v[76:79]
    v_mfma_f32_16x16x32_bf16 v[72:75], v[144:147], v[168:171], v[72:75]
    v_mfma_f32_16x16x32_bf16 v[80:83], v[148:151], v[160:163], v[80:83]
    v_mfma_f32_16x16x32_bf16 v[84:87], v[148:151], v[164:167], v[84:87]
    v_mfma_f32_16x16x32_bf16 v[92:95], v[148:151], v[172:175], v[92:95]
    v_mfma_f32_16x16x32_bf16 v[88:91], v[148:151], v[168:171], v[88:91]
    v_mfma_f32_16x16x32_bf16 v[96:99], v[152:155], v[160:163], v[96:99]
    v_mfma_f32_16x16x32_bf16 v[100:103], v[152:155], v[164:167], v[100:103]
    v_mfma_f32_16x16x32_bf16 v[108:111], v[152:155], v[172:175], v[108:111]
    v_mfma_f32_16x16x32_bf16 v[104:107], v[152:155], v[168:171], v[104:107]
    v_mfma_f32_16x16x32_bf16 v[112:115], v[156:159], v[160:163], v[112:115]
    v_mfma_f32_16x16x32_bf16 v[116:119], v[156:159], v[164:167], v[116:119]
    v_mfma_f32_16x16x32_bf16 v[124:127], v[156:159], v[172:175], v[124:127]
    v_mfma_f32_16x16x32_bf16 v[120:123], v[156:159], v[168:171], v[120:123]
    s_waitcnt lgkmcnt(0)
    s_barrier
    v_cndmask_b32 v216, v216, v243, s[60:61]
    v_cndmask_b32 v217, v217, v243, s[60:61]
    v_cndmask_b32 v218, v218, v243, s[60:61]
    v_cndmask_b32 v219, v219, v243, s[60:61]
    v_mfma_f32_16x16x32_bf16 v[0:3], v[176:179], v[208:211], v[0:3]
    ds_read_b64_tr_b16 v[160:161], v232 offset:49152
    v_mfma_f32_16x16x32_bf16 v[4:7], v[176:179], v[212:215], v[4:7]
    ds_read_b64_tr_b16 v[162:163], v232 offset:50176
    v_mfma_f32_16x16x32_bf16 v[12:15], v[176:179], v[220:223], v[12:15]
    ds_read_b64_tr_b16 v[164:165], v233 offset:49152
    v_mfma_f32_16x16x32_bf16 v[8:11], v[176:179], v[216:219], v[8:11]
    ds_read_b64_tr_b16 v[166:167], v233 offset:50176
    v_mfma_f32_16x16x32_bf16 v[16:19], v[180:183], v[208:211], v[16:19]
    ds_read_b64_tr_b16 v[168:169], v232 offset:57344
    v_mfma_f32_16x16x32_bf16 v[20:23], v[180:183], v[212:215], v[20:23]
    ds_read_b64_tr_b16 v[170:171], v232 offset:58368
    v_mfma_f32_16x16x32_bf16 v[28:31], v[180:183], v[220:223], v[28:31]
    ds_read_b64_tr_b16 v[172:173], v233 offset:57344
    v_mfma_f32_16x16x32_bf16 v[24:27], v[180:183], v[216:219], v[24:27]
    ds_read_b64_tr_b16 v[174:175], v233 offset:58368
    v_mfma_f32_16x16x32_bf16 v[32:35], v[184:187], v[208:211], v[32:35]
    ds_read_b128 v[128:131], v226 offset:32768
    v_mfma_f32_16x16x32_bf16 v[36:39], v[184:187], v[212:215], v[36:39]
    ds_read_b128 v[132:135], v226 offset:34816
    v_mfma_f32_16x16x32_bf16 v[44:47], v[184:187], v[220:223], v[44:47]
    ds_read_b128 v[136:139], v226 offset:36864
    v_mfma_f32_16x16x32_bf16 v[40:43], v[184:187], v[216:219], v[40:43]
    ds_read_b128 v[140:143], v226 offset:38912
    v_mfma_f32_16x16x32_bf16 v[48:51], v[188:191], v[208:211], v[48:51]
    ds_read_b128 v[144:147], v226 offset:40960
    v_mfma_f32_16x16x32_bf16 v[52:55], v[188:191], v[212:215], v[52:55]
    ds_read_b128 v[148:151], v226 offset:43008
    v_mfma_f32_16x16x32_bf16 v[60:63], v[188:191], v[220:223], v[60:63]
    ds_read_b128 v[152:155], v226 offset:45056
    v_mfma_f32_16x16x32_bf16 v[56:59], v[188:191], v[216:219], v[56:59]
    ds_read_b128 v[156:159], v226 offset:47104
    v_mfma_f32_16x16x32_bf16 v[64:67], v[192:195], v[208:211], v[64:67]
    v_mfma_f32_16x16x32_bf16 v[68:71], v[192:195], v[212:215], v[68:71]
    v_mfma_f32_16x16x32_bf16 v[76:79], v[192:195], v[220:223], v[76:79]
    v_mfma_f32_16x16x32_bf16 v[72:75], v[192:195], v[216:219], v[72:75]
    v_mfma_f32_16x16x32_bf16 v[80:83], v[196:199], v[208:211], v[80:83]
    v_mfma_f32_16x16x32_bf16 v[84:87], v[196:199], v[212:215], v[84:87]
    v_mfma_f32_16x16x32_bf16 v[92:95], v[196:199], v[220:223], v[92:95]
    v_mfma_f32_16x16x32_bf16 v[88:91], v[196:199], v[216:219], v[88:91]
    v_mfma_f32_16x16x32_bf16 v[96:99], v[200:203], v[208:211], v[96:99]
    v_mfma_f32_16x16x32_bf16 v[100:103], v[200:203], v[212:215], v[100:103]
    v_mfma_f32_16x16x32_bf16 v[108:111], v[200:203], v[220:223], v[108:111]
    v_mfma_f32_16x16x32_bf16 v[104:107], v[200:203], v[216:219], v[104:107]
    v_mfma_f32_16x16x32_bf16 v[112:115], v[204:207], v[208:211], v[112:115]
    v_mfma_f32_16x16x32_bf16 v[116:119], v[204:207], v[212:215], v[116:119]
    v_mfma_f32_16x16x32_bf16 v[124:127], v[204:207], v[220:223], v[124:127]
    v_mfma_f32_16x16x32_bf16 v[120:123], v[204:207], v[216:219], v[120:123]
    s_waitcnt lgkmcnt(0)
    s_barrier
    v_cndmask_b32 v168, v168, v243, s[60:61]
    v_cndmask_b32 v169, v169, v243, s[60:61]
    v_cndmask_b32 v170, v170, v243, s[60:61]
    v_cndmask_b32 v171, v171, v243, s[60:61]
    v_mfma_f32_16x16x32_bf16 v[0:3], v[128:131], v[160:163], v[0:3]
    ds_read_b64_tr_b16 v[208:209], v234 offset:0
    v_mfma_f32_16x16x32_bf16 v[4:7], v[128:131], v[164:167], v[4:7]
    ds_read_b64_tr_b16 v[210:211], v234 offset:1024
    v_mfma_f32_16x16x32_bf16 v[12:15], v[128:131], v[172:175], v[12:15]
    ds_read_b64_tr_b16 v[212:213], v235 offset:0
    v_mfma_f32_16x16x32_bf16 v[8:11], v[128:131], v[168:171], v[8:11]
    ds_read_b64_tr_b16 v[214:215], v235 offset:1024
    v_mfma_f32_16x16x32_bf16 v[16:19], v[132:135], v[160:163], v[16:19]
    ds_read_b64_tr_b16 v[216:217], v234 offset:8192
    v_mfma_f32_16x16x32_bf16 v[20:23], v[132:135], v[164:167], v[20:23]
    ds_read_b64_tr_b16 v[218:219], v234 offset:9216
    v_mfma_f32_16x16x32_bf16 v[28:31], v[132:135], v[172:175], v[28:31]
    ds_read_b64_tr_b16 v[220:221], v235 offset:8192
    v_mfma_f32_16x16x32_bf16 v[24:27], v[132:135], v[168:171], v[24:27]
    ds_read_b64_tr_b16 v[222:223], v235 offset:9216
    v_mfma_f32_16x16x32_bf16 v[32:35], v[136:139], v[160:163], v[32:35]
    ds_read_b128 v[176:179], v227 offset:32768
    v_mfma_f32_16x16x32_bf16 v[36:39], v[136:139], v[164:167], v[36:39]
    ds_read_b128 v[180:183], v227 offset:34816
    v_mfma_f32_16x16x32_bf16 v[44:47], v[136:139], v[172:175], v[44:47]
    ds_read_b128 v[184:187], v227 offset:36864
    v_mfma_f32_16x16x32_bf16 v[40:43], v[136:139], v[168:171], v[40:43]
    ds_read_b128 v[188:191], v227 offset:38912
    v_mfma_f32_16x16x32_bf16 v[48:51], v[140:143], v[160:163], v[48:51]
    ds_read_b128 v[192:195], v227 offset:40960
    v_mfma_f32_16x16x32_bf16 v[52:55], v[140:143], v[164:167], v[52:55]
    ds_read_b128 v[196:199], v227 offset:43008
    v_mfma_f32_16x16x32_bf16 v[60:63], v[140:143], v[172:175], v[60:63]
    ds_read_b128 v[200:203], v227 offset:45056
    v_mfma_f32_16x16x32_bf16 v[56:59], v[140:143], v[168:171], v[56:59]
    ds_read_b128 v[204:207], v227 offset:47104
    v_mfma_f32_16x16x32_bf16 v[64:67], v[144:147], v[160:163], v[64:67]
    v_mfma_f32_16x16x32_bf16 v[68:71], v[144:147], v[164:167], v[68:71]
    v_mfma_f32_16x16x32_bf16 v[76:79], v[144:147], v[172:175], v[76:79]
    v_mfma_f32_16x16x32_bf16 v[72:75], v[144:147], v[168:171], v[72:75]
    v_mfma_f32_16x16x32_bf16 v[80:83], v[148:151], v[160:163], v[80:83]
    v_mfma_f32_16x16x32_bf16 v[84:87], v[148:151], v[164:167], v[84:87]
    v_mfma_f32_16x16x32_bf16 v[92:95], v[148:151], v[172:175], v[92:95]
    v_mfma_f32_16x16x32_bf16 v[88:91], v[148:151], v[168:171], v[88:91]
    v_mfma_f32_16x16x32_bf16 v[96:99], v[152:155], v[160:163], v[96:99]
    v_mfma_f32_16x16x32_bf16 v[100:103], v[152:155], v[164:167], v[100:103]
    v_mfma_f32_16x16x32_bf16 v[108:111], v[152:155], v[172:175], v[108:111]
    v_mfma_f32_16x16x32_bf16 v[104:107], v[152:155], v[168:171], v[104:107]
    v_mfma_f32_16x16x32_bf16 v[112:115], v[156:159], v[160:163], v[112:115]
    v_mfma_f32_16x16x32_bf16 v[116:119], v[156:159], v[164:167], v[116:119]
    v_mfma_f32_16x16x32_bf16 v[124:127], v[156:159], v[172:175], v[124:127]
    v_mfma_f32_16x16x32_bf16 v[120:123], v[156:159], v[168:171], v[120:123]
    s_waitcnt lgkmcnt(0)
    s_barrier
    v_cndmask_b32 v216, v216, v243, s[60:61]
    v_cndmask_b32 v217, v217, v243, s[60:61]
    v_cndmask_b32 v218, v218, v243, s[60:61]
    v_cndmask_b32 v219, v219, v243, s[60:61]
    v_mfma_f32_16x16x32_bf16 v[0:3], v[176:179], v[208:211], v[0:3]
    ds_read_b64_tr_b16 v[160:161], v230 offset:16384
    v_mfma_f32_16x16x32_bf16 v[4:7], v[176:179], v[212:215], v[4:7]
    ds_read_b64_tr_b16 v[162:163], v230 offset:17408
    v_mfma_f32_16x16x32_bf16 v[12:15], v[176:179], v[220:223], v[12:15]
    ds_read_b64_tr_b16 v[164:165], v231 offset:16384
    v_mfma_f32_16x16x32_bf16 v[8:11], v[176:179], v[216:219], v[8:11]
    ds_read_b64_tr_b16 v[166:167], v231 offset:17408
    v_mfma_f32_16x16x32_bf16 v[16:19], v[180:183], v[208:211], v[16:19]
    ds_read_b64_tr_b16 v[168:169], v230 offset:24576
    v_mfma_f32_16x16x32_bf16 v[20:23], v[180:183], v[212:215], v[20:23]
    ds_read_b64_tr_b16 v[170:171], v230 offset:25600
    v_mfma_f32_16x16x32_bf16 v[28:31], v[180:183], v[220:223], v[28:31]
    ds_read_b64_tr_b16 v[172:173], v231 offset:24576
    v_mfma_f32_16x16x32_bf16 v[24:27], v[180:183], v[216:219], v[24:27]
    ds_read_b64_tr_b16 v[174:175], v231 offset:25600
    v_mfma_f32_16x16x32_bf16 v[32:35], v[184:187], v[208:211], v[32:35]
    ds_read_b128 v[128:131], v228 offset:16384
    v_mfma_f32_16x16x32_bf16 v[36:39], v[184:187], v[212:215], v[36:39]
    ds_read_b128 v[132:135], v228 offset:18432
    v_mfma_f32_16x16x32_bf16 v[44:47], v[184:187], v[220:223], v[44:47]
    ds_read_b128 v[136:139], v228 offset:20480
    v_mfma_f32_16x16x32_bf16 v[40:43], v[184:187], v[216:219], v[40:43]
    ds_read_b128 v[140:143], v228 offset:22528
    v_mfma_f32_16x16x32_bf16 v[48:51], v[188:191], v[208:211], v[48:51]
    ds_read_b128 v[144:147], v228 offset:24576
    v_mfma_f32_16x16x32_bf16 v[52:55], v[188:191], v[212:215], v[52:55]
    ds_read_b128 v[148:151], v228 offset:26624
    v_mfma_f32_16x16x32_bf16 v[60:63], v[188:191], v[220:223], v[60:63]
    ds_read_b128 v[152:155], v228 offset:28672
    v_mfma_f32_16x16x32_bf16 v[56:59], v[188:191], v[216:219], v[56:59]
    ds_read_b128 v[156:159], v228 offset:30720
    v_mfma_f32_16x16x32_bf16 v[64:67], v[192:195], v[208:211], v[64:67]
    v_mfma_f32_16x16x32_bf16 v[68:71], v[192:195], v[212:215], v[68:71]
    v_mfma_f32_16x16x32_bf16 v[76:79], v[192:195], v[220:223], v[76:79]
    v_mfma_f32_16x16x32_bf16 v[72:75], v[192:195], v[216:219], v[72:75]
    v_mfma_f32_16x16x32_bf16 v[80:83], v[196:199], v[208:211], v[80:83]
    v_mfma_f32_16x16x32_bf16 v[84:87], v[196:199], v[212:215], v[84:87]
    v_mfma_f32_16x16x32_bf16 v[92:95], v[196:199], v[220:223], v[92:95]
    v_mfma_f32_16x16x32_bf16 v[88:91], v[196:199], v[216:219], v[88:91]
    v_mfma_f32_16x16x32_bf16 v[96:99], v[200:203], v[208:211], v[96:99]
    v_mfma_f32_16x16x32_bf16 v[100:103], v[200:203], v[212:215], v[100:103]
    v_mfma_f32_16x16x32_bf16 v[108:111], v[200:203], v[220:223], v[108:111]
    v_mfma_f32_16x16x32_bf16 v[104:107], v[200:203], v[216:219], v[104:107]
    v_mfma_f32_16x16x32_bf16 v[112:115], v[204:207], v[208:211], v[112:115]
    v_mfma_f32_16x16x32_bf16 v[116:119], v[204:207], v[212:215], v[116:119]
    v_mfma_f32_16x16x32_bf16 v[124:127], v[204:207], v[220:223], v[124:127]
    v_mfma_f32_16x16x32_bf16 v[120:123], v[204:207], v[216:219], v[120:123]
    s_waitcnt lgkmcnt(0)
    s_barrier
    v_cndmask_b32 v168, v168, v243, s[60:61]
    v_cndmask_b32 v169, v169, v243, s[60:61]
    v_cndmask_b32 v170, v170, v243, s[60:61]
    v_cndmask_b32 v171, v171, v243, s[60:61]
    v_mfma_f32_16x16x32_bf16 v[0:3], v[128:131], v[160:163], v[0:3]
    ds_read_b64_tr_b16 v[208:209], v230 offset:32768
    v_mfma_f32_16x16x32_bf16 v[4:7], v[128:131], v[164:167], v[4:7]
    ds_read_b64_tr_b16 v[210:211], v230 offset:33792
    v_mfma_f32_16x16x32_bf16 v[12:15], v[128:131], v[172:175], v[12:15]
    ds_read_b64_tr_b16 v[212:213], v231 offset:32768
    v_mfma_f32_16x16x32_bf16 v[8:11], v[128:131], v[168:171], v[8:11]
    ds_read_b64_tr_b16 v[214:215], v231 offset:33792
    v_mfma_f32_16x16x32_bf16 v[16:19], v[132:135], v[160:163], v[16:19]
    ds_read_b64_tr_b16 v[216:217], v230 offset:40960
    v_mfma_f32_16x16x32_bf16 v[20:23], v[132:135], v[164:167], v[20:23]
    ds_read_b64_tr_b16 v[218:219], v230 offset:41984
    v_mfma_f32_16x16x32_bf16 v[28:31], v[132:135], v[172:175], v[28:31]
    ds_read_b64_tr_b16 v[220:221], v231 offset:40960
    v_mfma_f32_16x16x32_bf16 v[24:27], v[132:135], v[168:171], v[24:27]
    ds_read_b64_tr_b16 v[222:223], v231 offset:41984
    v_mfma_f32_16x16x32_bf16 v[32:35], v[136:139], v[160:163], v[32:35]
    ds_read_b128 v[176:179], v229 offset:16384
    v_mfma_f32_16x16x32_bf16 v[36:39], v[136:139], v[164:167], v[36:39]
    ds_read_b128 v[180:183], v229 offset:18432
    v_mfma_f32_16x16x32_bf16 v[44:47], v[136:139], v[172:175], v[44:47]
    ds_read_b128 v[184:187], v229 offset:20480
    v_mfma_f32_16x16x32_bf16 v[40:43], v[136:139], v[168:171], v[40:43]
    ds_read_b128 v[188:191], v229 offset:22528
    v_mfma_f32_16x16x32_bf16 v[48:51], v[140:143], v[160:163], v[48:51]
    ds_read_b128 v[192:195], v229 offset:24576
    v_mfma_f32_16x16x32_bf16 v[52:55], v[140:143], v[164:167], v[52:55]
    ds_read_b128 v[196:199], v229 offset:26624
    v_mfma_f32_16x16x32_bf16 v[60:63], v[140:143], v[172:175], v[60:63]
    ds_read_b128 v[200:203], v229 offset:28672
    v_mfma_f32_16x16x32_bf16 v[56:59], v[140:143], v[168:171], v[56:59]
    ds_read_b128 v[204:207], v229 offset:30720
    v_mfma_f32_16x16x32_bf16 v[64:67], v[144:147], v[160:163], v[64:67]
    v_mfma_f32_16x16x32_bf16 v[68:71], v[144:147], v[164:167], v[68:71]
    v_mfma_f32_16x16x32_bf16 v[76:79], v[144:147], v[172:175], v[76:79]
    v_mfma_f32_16x16x32_bf16 v[72:75], v[144:147], v[168:171], v[72:75]
    v_mfma_f32_16x16x32_bf16 v[80:83], v[148:151], v[160:163], v[80:83]
    v_mfma_f32_16x16x32_bf16 v[84:87], v[148:151], v[164:167], v[84:87]
    v_mfma_f32_16x16x32_bf16 v[92:95], v[148:151], v[172:175], v[92:95]
    v_mfma_f32_16x16x32_bf16 v[88:91], v[148:151], v[168:171], v[88:91]
    v_mfma_f32_16x16x32_bf16 v[96:99], v[152:155], v[160:163], v[96:99]
    v_mfma_f32_16x16x32_bf16 v[100:103], v[152:155], v[164:167], v[100:103]
    v_mfma_f32_16x16x32_bf16 v[108:111], v[152:155], v[172:175], v[108:111]
    v_mfma_f32_16x16x32_bf16 v[104:107], v[152:155], v[168:171], v[104:107]
    v_mfma_f32_16x16x32_bf16 v[112:115], v[156:159], v[160:163], v[112:115]
    v_mfma_f32_16x16x32_bf16 v[116:119], v[156:159], v[164:167], v[116:119]
    v_mfma_f32_16x16x32_bf16 v[124:127], v[156:159], v[172:175], v[124:127]
    v_mfma_f32_16x16x32_bf16 v[120:123], v[156:159], v[168:171], v[120:123]
    s_waitcnt lgkmcnt(0)
    s_barrier
    v_cndmask_b32 v216, v216, v243, s[60:61]
    v_cndmask_b32 v217, v217, v243, s[60:61]
    v_cndmask_b32 v218, v218, v243, s[60:61]
    v_cndmask_b32 v219, v219, v243, s[60:61]
    v_mfma_f32_16x16x32_bf16 v[0:3], v[176:179], v[208:211], v[0:3]
    ds_read_b64_tr_b16 v[160:161], v232 offset:0
    v_mfma_f32_16x16x32_bf16 v[4:7], v[176:179], v[212:215], v[4:7]
    ds_read_b64_tr_b16 v[162:163], v232 offset:1024
    v_mfma_f32_16x16x32_bf16 v[12:15], v[176:179], v[220:223], v[12:15]
    ds_read_b64_tr_b16 v[164:165], v233 offset:0
    v_mfma_f32_16x16x32_bf16 v[8:11], v[176:179], v[216:219], v[8:11]
    ds_read_b64_tr_b16 v[166:167], v233 offset:1024
    v_mfma_f32_16x16x32_bf16 v[16:19], v[180:183], v[208:211], v[16:19]
    ds_read_b64_tr_b16 v[168:169], v232 offset:8192
    v_mfma_f32_16x16x32_bf16 v[20:23], v[180:183], v[212:215], v[20:23]
    ds_read_b64_tr_b16 v[170:171], v232 offset:9216
    v_mfma_f32_16x16x32_bf16 v[28:31], v[180:183], v[220:223], v[28:31]
    ds_read_b64_tr_b16 v[172:173], v233 offset:8192
    v_mfma_f32_16x16x32_bf16 v[24:27], v[180:183], v[216:219], v[24:27]
    ds_read_b64_tr_b16 v[174:175], v233 offset:9216
    v_mfma_f32_16x16x32_bf16 v[32:35], v[184:187], v[208:211], v[32:35]
    ds_read_b128 v[128:131], v224 offset:0
    v_mfma_f32_16x16x32_bf16 v[36:39], v[184:187], v[212:215], v[36:39]
    ds_read_b128 v[132:135], v224 offset:2048
    v_mfma_f32_16x16x32_bf16 v[44:47], v[184:187], v[220:223], v[44:47]
    ds_read_b128 v[136:139], v224 offset:4096
    v_mfma_f32_16x16x32_bf16 v[40:43], v[184:187], v[216:219], v[40:43]
    ds_read_b128 v[140:143], v224 offset:6144
    v_mfma_f32_16x16x32_bf16 v[48:51], v[188:191], v[208:211], v[48:51]
    ds_read_b128 v[144:147], v224 offset:8192
    v_mfma_f32_16x16x32_bf16 v[52:55], v[188:191], v[212:215], v[52:55]
    ds_read_b128 v[148:151], v224 offset:10240
    v_mfma_f32_16x16x32_bf16 v[60:63], v[188:191], v[220:223], v[60:63]
    ds_read_b128 v[152:155], v224 offset:12288
    v_mfma_f32_16x16x32_bf16 v[56:59], v[188:191], v[216:219], v[56:59]
    ds_read_b128 v[156:159], v224 offset:14336
    v_mfma_f32_16x16x32_bf16 v[64:67], v[192:195], v[208:211], v[64:67]
    v_mfma_f32_16x16x32_bf16 v[68:71], v[192:195], v[212:215], v[68:71]
    v_mfma_f32_16x16x32_bf16 v[76:79], v[192:195], v[220:223], v[76:79]
    v_mfma_f32_16x16x32_bf16 v[72:75], v[192:195], v[216:219], v[72:75]
    v_mfma_f32_16x16x32_bf16 v[80:83], v[196:199], v[208:211], v[80:83]
    v_mfma_f32_16x16x32_bf16 v[84:87], v[196:199], v[212:215], v[84:87]
    v_mfma_f32_16x16x32_bf16 v[92:95], v[196:199], v[220:223], v[92:95]
    v_mfma_f32_16x16x32_bf16 v[88:91], v[196:199], v[216:219], v[88:91]
    v_mfma_f32_16x16x32_bf16 v[96:99], v[200:203], v[208:211], v[96:99]
    v_mfma_f32_16x16x32_bf16 v[100:103], v[200:203], v[212:215], v[100:103]
    v_mfma_f32_16x16x32_bf16 v[108:111], v[200:203], v[220:223], v[108:111]
    v_mfma_f32_16x16x32_bf16 v[104:107], v[200:203], v[216:219], v[104:107]
    v_mfma_f32_16x16x32_bf16 v[112:115], v[204:207], v[208:211], v[112:115]
    v_mfma_f32_16x16x32_bf16 v[116:119], v[204:207], v[212:215], v[116:119]
    v_mfma_f32_16x16x32_bf16 v[124:127], v[204:207], v[220:223], v[124:127]
    v_mfma_f32_16x16x32_bf16 v[120:123], v[204:207], v[216:219], v[120:123]
    s_waitcnt lgkmcnt(0)
    s_barrier
    v_cndmask_b32 v168, v168, v243, s[60:61]
    v_cndmask_b32 v169, v169, v243, s[60:61]
    v_cndmask_b32 v170, v170, v243, s[60:61]
    v_cndmask_b32 v171, v171, v243, s[60:61]
    v_mfma_f32_16x16x32_bf16 v[0:3], v[128:131], v[160:163], v[0:3]
    ds_read_b64_tr_b16 v[208:209], v232 offset:16384
    v_mfma_f32_16x16x32_bf16 v[4:7], v[128:131], v[164:167], v[4:7]
    ds_read_b64_tr_b16 v[210:211], v232 offset:17408
    v_mfma_f32_16x16x32_bf16 v[12:15], v[128:131], v[172:175], v[12:15]
    ds_read_b64_tr_b16 v[212:213], v233 offset:16384
    v_mfma_f32_16x16x32_bf16 v[8:11], v[128:131], v[168:171], v[8:11]
    ds_read_b64_tr_b16 v[214:215], v233 offset:17408
    v_mfma_f32_16x16x32_bf16 v[16:19], v[132:135], v[160:163], v[16:19]
    ds_read_b64_tr_b16 v[216:217], v232 offset:24576
    v_mfma_f32_16x16x32_bf16 v[20:23], v[132:135], v[164:167], v[20:23]
    ds_read_b64_tr_b16 v[218:219], v232 offset:25600
    v_mfma_f32_16x16x32_bf16 v[28:31], v[132:135], v[172:175], v[28:31]
    ds_read_b64_tr_b16 v[220:221], v233 offset:24576
    v_mfma_f32_16x16x32_bf16 v[24:27], v[132:135], v[168:171], v[24:27]
    ds_read_b64_tr_b16 v[222:223], v233 offset:25600
    v_mfma_f32_16x16x32_bf16 v[32:35], v[136:139], v[160:163], v[32:35]
    ds_read_b128 v[176:179], v225 offset:0
    v_mfma_f32_16x16x32_bf16 v[36:39], v[136:139], v[164:167], v[36:39]
    ds_read_b128 v[180:183], v225 offset:2048
    v_mfma_f32_16x16x32_bf16 v[44:47], v[136:139], v[172:175], v[44:47]
    ds_read_b128 v[184:187], v225 offset:4096
    v_mfma_f32_16x16x32_bf16 v[40:43], v[136:139], v[168:171], v[40:43]
    ds_read_b128 v[188:191], v225 offset:6144
    v_mfma_f32_16x16x32_bf16 v[48:51], v[140:143], v[160:163], v[48:51]
    ds_read_b128 v[192:195], v225 offset:8192
    v_mfma_f32_16x16x32_bf16 v[52:55], v[140:143], v[164:167], v[52:55]
    ds_read_b128 v[196:199], v225 offset:10240
    v_mfma_f32_16x16x32_bf16 v[60:63], v[140:143], v[172:175], v[60:63]
    ds_read_b128 v[200:203], v225 offset:12288
    v_mfma_f32_16x16x32_bf16 v[56:59], v[140:143], v[168:171], v[56:59]
    ds_read_b128 v[204:207], v225 offset:14336
    v_mfma_f32_16x16x32_bf16 v[64:67], v[144:147], v[160:163], v[64:67]
    v_mfma_f32_16x16x32_bf16 v[68:71], v[144:147], v[164:167], v[68:71]
    v_mfma_f32_16x16x32_bf16 v[76:79], v[144:147], v[172:175], v[76:79]
    v_mfma_f32_16x16x32_bf16 v[72:75], v[144:147], v[168:171], v[72:75]
    v_mfma_f32_16x16x32_bf16 v[80:83], v[148:151], v[160:163], v[80:83]
    v_mfma_f32_16x16x32_bf16 v[84:87], v[148:151], v[164:167], v[84:87]
    v_mfma_f32_16x16x32_bf16 v[92:95], v[148:151], v[172:175], v[92:95]
    v_mfma_f32_16x16x32_bf16 v[88:91], v[148:151], v[168:171], v[88:91]
    v_mfma_f32_16x16x32_bf16 v[96:99], v[152:155], v[160:163], v[96:99]
    v_mfma_f32_16x16x32_bf16 v[100:103], v[152:155], v[164:167], v[100:103]
    v_mfma_f32_16x16x32_bf16 v[108:111], v[152:155], v[172:175], v[108:111]
    v_mfma_f32_16x16x32_bf16 v[104:107], v[152:155], v[168:171], v[104:107]
    v_mfma_f32_16x16x32_bf16 v[112:115], v[156:159], v[160:163], v[112:115]
    v_mfma_f32_16x16x32_bf16 v[116:119], v[156:159], v[164:167], v[116:119]
    v_mfma_f32_16x16x32_bf16 v[124:127], v[156:159], v[172:175], v[124:127]
    v_mfma_f32_16x16x32_bf16 v[120:123], v[156:159], v[168:171], v[120:123]
    s_waitcnt lgkmcnt(0)
    s_barrier
    v_cndmask_b32 v216, v216, v243, s[60:61]
    v_cndmask_b32 v217, v217, v243, s[60:61]
    v_cndmask_b32 v218, v218, v243, s[60:61]
    v_cndmask_b32 v219, v219, v243, s[60:61]
    v_mfma_f32_16x16x32_bf16 v[0:3], v[176:179], v[208:211], v[0:3]
    ds_read_b64_tr_b16 v[160:161], v232 offset:49152
    v_mfma_f32_16x16x32_bf16 v[4:7], v[176:179], v[212:215], v[4:7]
    ds_read_b64_tr_b16 v[162:163], v232 offset:50176
    v_mfma_f32_16x16x32_bf16 v[12:15], v[176:179], v[220:223], v[12:15]
    ds_read_b64_tr_b16 v[164:165], v233 offset:49152
    v_mfma_f32_16x16x32_bf16 v[8:11], v[176:179], v[216:219], v[8:11]
    ds_read_b64_tr_b16 v[166:167], v233 offset:50176
    v_mfma_f32_16x16x32_bf16 v[16:19], v[180:183], v[208:211], v[16:19]
    ds_read_b64_tr_b16 v[168:169], v232 offset:57344
    v_mfma_f32_16x16x32_bf16 v[20:23], v[180:183], v[212:215], v[20:23]
    ds_read_b64_tr_b16 v[170:171], v232 offset:58368
    v_mfma_f32_16x16x32_bf16 v[28:31], v[180:183], v[220:223], v[28:31]
    ds_read_b64_tr_b16 v[172:173], v233 offset:57344
    v_mfma_f32_16x16x32_bf16 v[24:27], v[180:183], v[216:219], v[24:27]
    ds_read_b64_tr_b16 v[174:175], v233 offset:58368
    v_mfma_f32_16x16x32_bf16 v[32:35], v[184:187], v[208:211], v[32:35]
    ds_read_b128 v[128:131], v224 offset:49152
    v_mfma_f32_16x16x32_bf16 v[36:39], v[184:187], v[212:215], v[36:39]
    ds_read_b128 v[132:135], v224 offset:51200
    v_mfma_f32_16x16x32_bf16 v[44:47], v[184:187], v[220:223], v[44:47]
    ds_read_b128 v[136:139], v224 offset:53248
    v_mfma_f32_16x16x32_bf16 v[40:43], v[184:187], v[216:219], v[40:43]
    ds_read_b128 v[140:143], v224 offset:55296
    v_mfma_f32_16x16x32_bf16 v[48:51], v[188:191], v[208:211], v[48:51]
    ds_read_b128 v[144:147], v224 offset:57344
    v_mfma_f32_16x16x32_bf16 v[52:55], v[188:191], v[212:215], v[52:55]
    ds_read_b128 v[148:151], v224 offset:59392
    v_mfma_f32_16x16x32_bf16 v[60:63], v[188:191], v[220:223], v[60:63]
    ds_read_b128 v[152:155], v224 offset:61440
    v_mfma_f32_16x16x32_bf16 v[56:59], v[188:191], v[216:219], v[56:59]
    ds_read_b128 v[156:159], v224 offset:63488
    v_mfma_f32_16x16x32_bf16 v[64:67], v[192:195], v[208:211], v[64:67]
    v_mfma_f32_16x16x32_bf16 v[68:71], v[192:195], v[212:215], v[68:71]
    v_mfma_f32_16x16x32_bf16 v[76:79], v[192:195], v[220:223], v[76:79]
    v_mfma_f32_16x16x32_bf16 v[72:75], v[192:195], v[216:219], v[72:75]
    v_mfma_f32_16x16x32_bf16 v[80:83], v[196:199], v[208:211], v[80:83]
    v_mfma_f32_16x16x32_bf16 v[84:87], v[196:199], v[212:215], v[84:87]
    v_mfma_f32_16x16x32_bf16 v[92:95], v[196:199], v[220:223], v[92:95]
    v_mfma_f32_16x16x32_bf16 v[88:91], v[196:199], v[216:219], v[88:91]
    v_mfma_f32_16x16x32_bf16 v[96:99], v[200:203], v[208:211], v[96:99]
    v_mfma_f32_16x16x32_bf16 v[100:103], v[200:203], v[212:215], v[100:103]
    v_mfma_f32_16x16x32_bf16 v[108:111], v[200:203], v[220:223], v[108:111]
    v_mfma_f32_16x16x32_bf16 v[104:107], v[200:203], v[216:219], v[104:107]
    v_mfma_f32_16x16x32_bf16 v[112:115], v[204:207], v[208:211], v[112:115]
    v_mfma_f32_16x16x32_bf16 v[116:119], v[204:207], v[212:215], v[116:119]
    v_mfma_f32_16x16x32_bf16 v[124:127], v[204:207], v[220:223], v[124:127]
    v_mfma_f32_16x16x32_bf16 v[120:123], v[204:207], v[216:219], v[120:123]
    s_waitcnt lgkmcnt(0)
    s_barrier
    v_cndmask_b32 v168, v168, v243, s[60:61]
    v_cndmask_b32 v169, v169, v243, s[60:61]
    v_cndmask_b32 v170, v170, v243, s[60:61]
    v_cndmask_b32 v171, v171, v243, s[60:61]
    v_mfma_f32_16x16x32_bf16 v[0:3], v[128:131], v[160:163], v[0:3]
    ds_read_b64_tr_b16 v[208:209], v234 offset:0
    v_mfma_f32_16x16x32_bf16 v[4:7], v[128:131], v[164:167], v[4:7]
    ds_read_b64_tr_b16 v[210:211], v234 offset:1024
    v_mfma_f32_16x16x32_bf16 v[12:15], v[128:131], v[172:175], v[12:15]
    ds_read_b64_tr_b16 v[212:213], v235 offset:0
    v_mfma_f32_16x16x32_bf16 v[8:11], v[128:131], v[168:171], v[8:11]
    ds_read_b64_tr_b16 v[214:215], v235 offset:1024
    v_mfma_f32_16x16x32_bf16 v[16:19], v[132:135], v[160:163], v[16:19]
    ds_read_b64_tr_b16 v[216:217], v234 offset:8192
    v_mfma_f32_16x16x32_bf16 v[20:23], v[132:135], v[164:167], v[20:23]
    ds_read_b64_tr_b16 v[218:219], v234 offset:9216
    v_mfma_f32_16x16x32_bf16 v[28:31], v[132:135], v[172:175], v[28:31]
    ds_read_b64_tr_b16 v[220:221], v235 offset:8192
    v_mfma_f32_16x16x32_bf16 v[24:27], v[132:135], v[168:171], v[24:27]
    ds_read_b64_tr_b16 v[222:223], v235 offset:9216
    v_mfma_f32_16x16x32_bf16 v[32:35], v[136:139], v[160:163], v[32:35]
    ds_read_b128 v[176:179], v225 offset:49152
    v_mfma_f32_16x16x32_bf16 v[36:39], v[136:139], v[164:167], v[36:39]
    ds_read_b128 v[180:183], v225 offset:51200
    v_mfma_f32_16x16x32_bf16 v[44:47], v[136:139], v[172:175], v[44:47]
    ds_read_b128 v[184:187], v225 offset:53248
    v_mfma_f32_16x16x32_bf16 v[40:43], v[136:139], v[168:171], v[40:43]
    ds_read_b128 v[188:191], v225 offset:55296
    v_mfma_f32_16x16x32_bf16 v[48:51], v[140:143], v[160:163], v[48:51]
    ds_read_b128 v[192:195], v225 offset:57344
    v_mfma_f32_16x16x32_bf16 v[52:55], v[140:143], v[164:167], v[52:55]
    ds_read_b128 v[196:199], v225 offset:59392
    v_mfma_f32_16x16x32_bf16 v[60:63], v[140:143], v[172:175], v[60:63]
    ds_read_b128 v[200:203], v225 offset:61440
    v_mfma_f32_16x16x32_bf16 v[56:59], v[140:143], v[168:171], v[56:59]
    ds_read_b128 v[204:207], v225 offset:63488
    v_mfma_f32_16x16x32_bf16 v[64:67], v[144:147], v[160:163], v[64:67]
    v_mfma_f32_16x16x32_bf16 v[68:71], v[144:147], v[164:167], v[68:71]
    v_mfma_f32_16x16x32_bf16 v[76:79], v[144:147], v[172:175], v[76:79]
    v_mfma_f32_16x16x32_bf16 v[72:75], v[144:147], v[168:171], v[72:75]
    v_mfma_f32_16x16x32_bf16 v[80:83], v[148:151], v[160:163], v[80:83]
    v_mfma_f32_16x16x32_bf16 v[84:87], v[148:151], v[164:167], v[84:87]
    v_mfma_f32_16x16x32_bf16 v[92:95], v[148:151], v[172:175], v[92:95]
    v_mfma_f32_16x16x32_bf16 v[88:91], v[148:151], v[168:171], v[88:91]
    v_mfma_f32_16x16x32_bf16 v[96:99], v[152:155], v[160:163], v[96:99]
    v_mfma_f32_16x16x32_bf16 v[100:103], v[152:155], v[164:167], v[100:103]
    v_mfma_f32_16x16x32_bf16 v[108:111], v[152:155], v[172:175], v[108:111]
    v_mfma_f32_16x16x32_bf16 v[104:107], v[152:155], v[168:171], v[104:107]
    v_mfma_f32_16x16x32_bf16 v[112:115], v[156:159], v[160:163], v[112:115]
    v_mfma_f32_16x16x32_bf16 v[116:119], v[156:159], v[164:167], v[116:119]
    v_mfma_f32_16x16x32_bf16 v[124:127], v[156:159], v[172:175], v[124:127]
    v_mfma_f32_16x16x32_bf16 v[120:123], v[156:159], v[168:171], v[120:123]
    s_waitcnt lgkmcnt(0)
    s_barrier
    v_cndmask_b32 v216, v216, v243, s[60:61]
    v_cndmask_b32 v217, v217, v243, s[60:61]
    v_cndmask_b32 v218, v218, v243, s[60:61]
    v_cndmask_b32 v219, v219, v243, s[60:61]
    v_mfma_f32_16x16x32_bf16 v[0:3], v[176:179], v[208:211], v[0:3]
    ds_read_b64_tr_b16 v[160:161], v230 offset:16384
    v_mfma_f32_16x16x32_bf16 v[4:7], v[176:179], v[212:215], v[4:7]
    ds_read_b64_tr_b16 v[162:163], v230 offset:17408
    v_mfma_f32_16x16x32_bf16 v[12:15], v[176:179], v[220:223], v[12:15]
    ds_read_b64_tr_b16 v[164:165], v231 offset:16384
    v_mfma_f32_16x16x32_bf16 v[8:11], v[176:179], v[216:219], v[8:11]
    ds_read_b64_tr_b16 v[166:167], v231 offset:17408
    v_mfma_f32_16x16x32_bf16 v[16:19], v[180:183], v[208:211], v[16:19]
    ds_read_b64_tr_b16 v[168:169], v230 offset:24576
    v_mfma_f32_16x16x32_bf16 v[20:23], v[180:183], v[212:215], v[20:23]
    ds_read_b64_tr_b16 v[170:171], v230 offset:25600
    v_mfma_f32_16x16x32_bf16 v[28:31], v[180:183], v[220:223], v[28:31]
    ds_read_b64_tr_b16 v[172:173], v231 offset:24576
    v_mfma_f32_16x16x32_bf16 v[24:27], v[180:183], v[216:219], v[24:27]
    ds_read_b64_tr_b16 v[174:175], v231 offset:25600
    v_mfma_f32_16x16x32_bf16 v[32:35], v[184:187], v[208:211], v[32:35]
    ds_read_b128 v[128:131], v226 offset:32768
    v_mfma_f32_16x16x32_bf16 v[36:39], v[184:187], v[212:215], v[36:39]
    ds_read_b128 v[132:135], v226 offset:34816
    v_mfma_f32_16x16x32_bf16 v[44:47], v[184:187], v[220:223], v[44:47]
    ds_read_b128 v[136:139], v226 offset:36864
    v_mfma_f32_16x16x32_bf16 v[40:43], v[184:187], v[216:219], v[40:43]
    ds_read_b128 v[140:143], v226 offset:38912
    v_mfma_f32_16x16x32_bf16 v[48:51], v[188:191], v[208:211], v[48:51]
    ds_read_b128 v[144:147], v226 offset:40960
    v_mfma_f32_16x16x32_bf16 v[52:55], v[188:191], v[212:215], v[52:55]
    ds_read_b128 v[148:151], v226 offset:43008
    v_mfma_f32_16x16x32_bf16 v[60:63], v[188:191], v[220:223], v[60:63]
    ds_read_b128 v[152:155], v226 offset:45056
    v_mfma_f32_16x16x32_bf16 v[56:59], v[188:191], v[216:219], v[56:59]
    ds_read_b128 v[156:159], v226 offset:47104
    v_mfma_f32_16x16x32_bf16 v[64:67], v[192:195], v[208:211], v[64:67]
    v_mfma_f32_16x16x32_bf16 v[68:71], v[192:195], v[212:215], v[68:71]
    v_mfma_f32_16x16x32_bf16 v[76:79], v[192:195], v[220:223], v[76:79]
    v_mfma_f32_16x16x32_bf16 v[72:75], v[192:195], v[216:219], v[72:75]
    v_mfma_f32_16x16x32_bf16 v[80:83], v[196:199], v[208:211], v[80:83]
    v_mfma_f32_16x16x32_bf16 v[84:87], v[196:199], v[212:215], v[84:87]
    v_mfma_f32_16x16x32_bf16 v[92:95], v[196:199], v[220:223], v[92:95]
    v_mfma_f32_16x16x32_bf16 v[88:91], v[196:199], v[216:219], v[88:91]
    v_mfma_f32_16x16x32_bf16 v[96:99], v[200:203], v[208:211], v[96:99]
    v_mfma_f32_16x16x32_bf16 v[100:103], v[200:203], v[212:215], v[100:103]
    v_mfma_f32_16x16x32_bf16 v[108:111], v[200:203], v[220:223], v[108:111]
    v_mfma_f32_16x16x32_bf16 v[104:107], v[200:203], v[216:219], v[104:107]
    v_mfma_f32_16x16x32_bf16 v[112:115], v[204:207], v[208:211], v[112:115]
    v_mfma_f32_16x16x32_bf16 v[116:119], v[204:207], v[212:215], v[116:119]
    v_mfma_f32_16x16x32_bf16 v[124:127], v[204:207], v[220:223], v[124:127]
    v_mfma_f32_16x16x32_bf16 v[120:123], v[204:207], v[216:219], v[120:123]
    s_waitcnt lgkmcnt(0)
    s_barrier
    v_cndmask_b32 v168, v168, v243, s[60:61]
    v_cndmask_b32 v169, v169, v243, s[60:61]
    v_cndmask_b32 v170, v170, v243, s[60:61]
    v_cndmask_b32 v171, v171, v243, s[60:61]
    v_mfma_f32_16x16x32_bf16 v[0:3], v[128:131], v[160:163], v[0:3]
    ds_read_b64_tr_b16 v[208:209], v230 offset:32768
    v_mfma_f32_16x16x32_bf16 v[4:7], v[128:131], v[164:167], v[4:7]
    ds_read_b64_tr_b16 v[210:211], v230 offset:33792
    v_mfma_f32_16x16x32_bf16 v[12:15], v[128:131], v[172:175], v[12:15]
    ds_read_b64_tr_b16 v[212:213], v231 offset:32768
    v_mfma_f32_16x16x32_bf16 v[8:11], v[128:131], v[168:171], v[8:11]
    ds_read_b64_tr_b16 v[214:215], v231 offset:33792
    v_mfma_f32_16x16x32_bf16 v[16:19], v[132:135], v[160:163], v[16:19]
    ds_read_b64_tr_b16 v[216:217], v230 offset:40960
    v_mfma_f32_16x16x32_bf16 v[20:23], v[132:135], v[164:167], v[20:23]
    ds_read_b64_tr_b16 v[218:219], v230 offset:41984
    v_mfma_f32_16x16x32_bf16 v[28:31], v[132:135], v[172:175], v[28:31]
    ds_read_b64_tr_b16 v[220:221], v231 offset:40960
    v_mfma_f32_16x16x32_bf16 v[24:27], v[132:135], v[168:171], v[24:27]
    ds_read_b64_tr_b16 v[222:223], v231 offset:41984
    v_mfma_f32_16x16x32_bf16 v[32:35], v[136:139], v[160:163], v[32:35]
    ds_read_b128 v[176:179], v227 offset:32768
    v_mfma_f32_16x16x32_bf16 v[36:39], v[136:139], v[164:167], v[36:39]
    ds_read_b128 v[180:183], v227 offset:34816
    v_mfma_f32_16x16x32_bf16 v[44:47], v[136:139], v[172:175], v[44:47]
    ds_read_b128 v[184:187], v227 offset:36864
    v_mfma_f32_16x16x32_bf16 v[40:43], v[136:139], v[168:171], v[40:43]
    ds_read_b128 v[188:191], v227 offset:38912
    v_mfma_f32_16x16x32_bf16 v[48:51], v[140:143], v[160:163], v[48:51]
    ds_read_b128 v[192:195], v227 offset:40960
    v_mfma_f32_16x16x32_bf16 v[52:55], v[140:143], v[164:167], v[52:55]
    ds_read_b128 v[196:199], v227 offset:43008
    v_mfma_f32_16x16x32_bf16 v[60:63], v[140:143], v[172:175], v[60:63]
    ds_read_b128 v[200:203], v227 offset:45056
    v_mfma_f32_16x16x32_bf16 v[56:59], v[140:143], v[168:171], v[56:59]
    ds_read_b128 v[204:207], v227 offset:47104
    v_mfma_f32_16x16x32_bf16 v[64:67], v[144:147], v[160:163], v[64:67]
    v_mfma_f32_16x16x32_bf16 v[68:71], v[144:147], v[164:167], v[68:71]
    v_mfma_f32_16x16x32_bf16 v[76:79], v[144:147], v[172:175], v[76:79]
    v_mfma_f32_16x16x32_bf16 v[72:75], v[144:147], v[168:171], v[72:75]
    v_mfma_f32_16x16x32_bf16 v[80:83], v[148:151], v[160:163], v[80:83]
    v_mfma_f32_16x16x32_bf16 v[84:87], v[148:151], v[164:167], v[84:87]
    v_mfma_f32_16x16x32_bf16 v[92:95], v[148:151], v[172:175], v[92:95]
    v_mfma_f32_16x16x32_bf16 v[88:91], v[148:151], v[168:171], v[88:91]
    v_mfma_f32_16x16x32_bf16 v[96:99], v[152:155], v[160:163], v[96:99]
    v_mfma_f32_16x16x32_bf16 v[100:103], v[152:155], v[164:167], v[100:103]
    v_mfma_f32_16x16x32_bf16 v[108:111], v[152:155], v[172:175], v[108:111]
    v_mfma_f32_16x16x32_bf16 v[104:107], v[152:155], v[168:171], v[104:107]
    v_mfma_f32_16x16x32_bf16 v[112:115], v[156:159], v[160:163], v[112:115]
    v_mfma_f32_16x16x32_bf16 v[116:119], v[156:159], v[164:167], v[116:119]
    v_mfma_f32_16x16x32_bf16 v[124:127], v[156:159], v[172:175], v[124:127]
    v_mfma_f32_16x16x32_bf16 v[120:123], v[156:159], v[168:171], v[120:123]
    s_waitcnt lgkmcnt(0)
    s_barrier
    v_cndmask_b32 v216, v216, v243, s[60:61]
    v_cndmask_b32 v217, v217, v243, s[60:61]
    v_cndmask_b32 v218, v218, v243, s[60:61]
    v_cndmask_b32 v219, v219, v243, s[60:61]
    v_mfma_f32_16x16x32_bf16 v[0:3], v[176:179], v[208:211], v[0:3]
    ds_read_b64_tr_b16 v[160:161], v232 offset:0
    v_mfma_f32_16x16x32_bf16 v[4:7], v[176:179], v[212:215], v[4:7]
    ds_read_b64_tr_b16 v[162:163], v232 offset:1024
    v_mfma_f32_16x16x32_bf16 v[12:15], v[176:179], v[220:223], v[12:15]
    ds_read_b64_tr_b16 v[164:165], v233 offset:0
    v_mfma_f32_16x16x32_bf16 v[8:11], v[176:179], v[216:219], v[8:11]
    ds_read_b64_tr_b16 v[166:167], v233 offset:1024
    v_mfma_f32_16x16x32_bf16 v[16:19], v[180:183], v[208:211], v[16:19]
    ds_read_b64_tr_b16 v[168:169], v232 offset:8192
    v_mfma_f32_16x16x32_bf16 v[20:23], v[180:183], v[212:215], v[20:23]
    ds_read_b64_tr_b16 v[170:171], v232 offset:9216
    v_mfma_f32_16x16x32_bf16 v[28:31], v[180:183], v[220:223], v[28:31]
    ds_read_b64_tr_b16 v[172:173], v233 offset:8192
    v_mfma_f32_16x16x32_bf16 v[24:27], v[180:183], v[216:219], v[24:27]
    ds_read_b64_tr_b16 v[174:175], v233 offset:9216
    v_mfma_f32_16x16x32_bf16 v[32:35], v[184:187], v[208:211], v[32:35]
    ds_read_b128 v[128:131], v228 offset:16384
    v_mfma_f32_16x16x32_bf16 v[36:39], v[184:187], v[212:215], v[36:39]
    ds_read_b128 v[132:135], v228 offset:18432
    v_mfma_f32_16x16x32_bf16 v[44:47], v[184:187], v[220:223], v[44:47]
    ds_read_b128 v[136:139], v228 offset:20480
    v_mfma_f32_16x16x32_bf16 v[40:43], v[184:187], v[216:219], v[40:43]
    ds_read_b128 v[140:143], v228 offset:22528
    v_mfma_f32_16x16x32_bf16 v[48:51], v[188:191], v[208:211], v[48:51]
    ds_read_b128 v[144:147], v228 offset:24576
    v_mfma_f32_16x16x32_bf16 v[52:55], v[188:191], v[212:215], v[52:55]
    ds_read_b128 v[148:151], v228 offset:26624
    v_mfma_f32_16x16x32_bf16 v[60:63], v[188:191], v[220:223], v[60:63]
    ds_read_b128 v[152:155], v228 offset:28672
    v_mfma_f32_16x16x32_bf16 v[56:59], v[188:191], v[216:219], v[56:59]
    ds_read_b128 v[156:159], v228 offset:30720
    v_mfma_f32_16x16x32_bf16 v[64:67], v[192:195], v[208:211], v[64:67]
    v_mfma_f32_16x16x32_bf16 v[68:71], v[192:195], v[212:215], v[68:71]
    v_mfma_f32_16x16x32_bf16 v[76:79], v[192:195], v[220:223], v[76:79]
    v_mfma_f32_16x16x32_bf16 v[72:75], v[192:195], v[216:219], v[72:75]
    v_mfma_f32_16x16x32_bf16 v[80:83], v[196:199], v[208:211], v[80:83]
    v_mfma_f32_16x16x32_bf16 v[84:87], v[196:199], v[212:215], v[84:87]
    v_mfma_f32_16x16x32_bf16 v[92:95], v[196:199], v[220:223], v[92:95]
    v_mfma_f32_16x16x32_bf16 v[88:91], v[196:199], v[216:219], v[88:91]
    v_mfma_f32_16x16x32_bf16 v[96:99], v[200:203], v[208:211], v[96:99]
    v_mfma_f32_16x16x32_bf16 v[100:103], v[200:203], v[212:215], v[100:103]
    v_mfma_f32_16x16x32_bf16 v[108:111], v[200:203], v[220:223], v[108:111]
    v_mfma_f32_16x16x32_bf16 v[104:107], v[200:203], v[216:219], v[104:107]
    v_mfma_f32_16x16x32_bf16 v[112:115], v[204:207], v[208:211], v[112:115]
    v_mfma_f32_16x16x32_bf16 v[116:119], v[204:207], v[212:215], v[116:119]
    v_mfma_f32_16x16x32_bf16 v[124:127], v[204:207], v[220:223], v[124:127]
    v_mfma_f32_16x16x32_bf16 v[120:123], v[204:207], v[216:219], v[120:123]
    s_waitcnt lgkmcnt(0)
    s_barrier
    v_cndmask_b32 v168, v168, v243, s[60:61]
    v_cndmask_b32 v169, v169, v243, s[60:61]
    v_cndmask_b32 v170, v170, v243, s[60:61]
    v_cndmask_b32 v171, v171, v243, s[60:61]
    v_mfma_f32_16x16x32_bf16 v[0:3], v[128:131], v[160:163], v[0:3]
    ds_read_b64_tr_b16 v[208:209], v232 offset:16384
    v_mfma_f32_16x16x32_bf16 v[4:7], v[128:131], v[164:167], v[4:7]
    ds_read_b64_tr_b16 v[210:211], v232 offset:17408
    v_mfma_f32_16x16x32_bf16 v[12:15], v[128:131], v[172:175], v[12:15]
    ds_read_b64_tr_b16 v[212:213], v233 offset:16384
    v_mfma_f32_16x16x32_bf16 v[8:11], v[128:131], v[168:171], v[8:11]
    ds_read_b64_tr_b16 v[214:215], v233 offset:17408
    v_mfma_f32_16x16x32_bf16 v[16:19], v[132:135], v[160:163], v[16:19]
    ds_read_b64_tr_b16 v[216:217], v232 offset:24576
    v_mfma_f32_16x16x32_bf16 v[20:23], v[132:135], v[164:167], v[20:23]
    ds_read_b64_tr_b16 v[218:219], v232 offset:25600
    v_mfma_f32_16x16x32_bf16 v[28:31], v[132:135], v[172:175], v[28:31]
    ds_read_b64_tr_b16 v[220:221], v233 offset:24576
    v_mfma_f32_16x16x32_bf16 v[24:27], v[132:135], v[168:171], v[24:27]
    ds_read_b64_tr_b16 v[222:223], v233 offset:25600
    v_mfma_f32_16x16x32_bf16 v[32:35], v[136:139], v[160:163], v[32:35]
    ds_read_b128 v[176:179], v229 offset:16384
    v_mfma_f32_16x16x32_bf16 v[36:39], v[136:139], v[164:167], v[36:39]
    ds_read_b128 v[180:183], v229 offset:18432
    v_mfma_f32_16x16x32_bf16 v[44:47], v[136:139], v[172:175], v[44:47]
    ds_read_b128 v[184:187], v229 offset:20480
    v_mfma_f32_16x16x32_bf16 v[40:43], v[136:139], v[168:171], v[40:43]
    ds_read_b128 v[188:191], v229 offset:22528
    v_mfma_f32_16x16x32_bf16 v[48:51], v[140:143], v[160:163], v[48:51]
    ds_read_b128 v[192:195], v229 offset:24576
    v_mfma_f32_16x16x32_bf16 v[52:55], v[140:143], v[164:167], v[52:55]
    ds_read_b128 v[196:199], v229 offset:26624
    v_mfma_f32_16x16x32_bf16 v[60:63], v[140:143], v[172:175], v[60:63]
    ds_read_b128 v[200:203], v229 offset:28672
    v_mfma_f32_16x16x32_bf16 v[56:59], v[140:143], v[168:171], v[56:59]
    ds_read_b128 v[204:207], v229 offset:30720
    v_mfma_f32_16x16x32_bf16 v[64:67], v[144:147], v[160:163], v[64:67]
    v_mfma_f32_16x16x32_bf16 v[68:71], v[144:147], v[164:167], v[68:71]
    v_mfma_f32_16x16x32_bf16 v[76:79], v[144:147], v[172:175], v[76:79]
    v_mfma_f32_16x16x32_bf16 v[72:75], v[144:147], v[168:171], v[72:75]
    v_mfma_f32_16x16x32_bf16 v[80:83], v[148:151], v[160:163], v[80:83]
    v_mfma_f32_16x16x32_bf16 v[84:87], v[148:151], v[164:167], v[84:87]
    v_mfma_f32_16x16x32_bf16 v[92:95], v[148:151], v[172:175], v[92:95]
    v_mfma_f32_16x16x32_bf16 v[88:91], v[148:151], v[168:171], v[88:91]
    v_mfma_f32_16x16x32_bf16 v[96:99], v[152:155], v[160:163], v[96:99]
    v_mfma_f32_16x16x32_bf16 v[100:103], v[152:155], v[164:167], v[100:103]
    v_mfma_f32_16x16x32_bf16 v[108:111], v[152:155], v[172:175], v[108:111]
    v_mfma_f32_16x16x32_bf16 v[104:107], v[152:155], v[168:171], v[104:107]
    v_mfma_f32_16x16x32_bf16 v[112:115], v[156:159], v[160:163], v[112:115]
    v_mfma_f32_16x16x32_bf16 v[116:119], v[156:159], v[164:167], v[116:119]
    v_mfma_f32_16x16x32_bf16 v[124:127], v[156:159], v[172:175], v[124:127]
    v_mfma_f32_16x16x32_bf16 v[120:123], v[156:159], v[168:171], v[120:123]
    s_waitcnt lgkmcnt(0)
    s_barrier
    v_cndmask_b32 v216, v216, v243, s[60:61]
    v_cndmask_b32 v217, v217, v243, s[60:61]
    v_cndmask_b32 v218, v218, v243, s[60:61]
    v_cndmask_b32 v219, v219, v243, s[60:61]
    v_mfma_f32_16x16x32_bf16 v[0:3], v[176:179], v[208:211], v[0:3]
    v_mfma_f32_16x16x32_bf16 v[4:7], v[176:179], v[212:215], v[4:7]
    v_mfma_f32_16x16x32_bf16 v[12:15], v[176:179], v[220:223], v[12:15]
    v_mfma_f32_16x16x32_bf16 v[8:11], v[176:179], v[216:219], v[8:11]
    v_mfma_f32_16x16x32_bf16 v[16:19], v[180:183], v[208:211], v[16:19]
    v_mfma_f32_16x16x32_bf16 v[20:23], v[180:183], v[212:215], v[20:23]
    v_mfma_f32_16x16x32_bf16 v[28:31], v[180:183], v[220:223], v[28:31]
    v_mfma_f32_16x16x32_bf16 v[24:27], v[180:183], v[216:219], v[24:27]
    v_mfma_f32_16x16x32_bf16 v[32:35], v[184:187], v[208:211], v[32:35]
    v_mfma_f32_16x16x32_bf16 v[36:39], v[184:187], v[212:215], v[36:39]
    v_mfma_f32_16x16x32_bf16 v[44:47], v[184:187], v[220:223], v[44:47]
    v_mfma_f32_16x16x32_bf16 v[40:43], v[184:187], v[216:219], v[40:43]
    v_mfma_f32_16x16x32_bf16 v[48:51], v[188:191], v[208:211], v[48:51]
    v_mfma_f32_16x16x32_bf16 v[52:55], v[188:191], v[212:215], v[52:55]
    v_mfma_f32_16x16x32_bf16 v[60:63], v[188:191], v[220:223], v[60:63]
    v_mfma_f32_16x16x32_bf16 v[56:59], v[188:191], v[216:219], v[56:59]
    v_mfma_f32_16x16x32_bf16 v[64:67], v[192:195], v[208:211], v[64:67]
    v_mfma_f32_16x16x32_bf16 v[68:71], v[192:195], v[212:215], v[68:71]
    v_mfma_f32_16x16x32_bf16 v[76:79], v[192:195], v[220:223], v[76:79]
    v_mfma_f32_16x16x32_bf16 v[72:75], v[192:195], v[216:219], v[72:75]
    v_mfma_f32_16x16x32_bf16 v[80:83], v[196:199], v[208:211], v[80:83]
    v_mfma_f32_16x16x32_bf16 v[84:87], v[196:199], v[212:215], v[84:87]
    v_mfma_f32_16x16x32_bf16 v[92:95], v[196:199], v[220:223], v[92:95]
    v_mfma_f32_16x16x32_bf16 v[88:91], v[196:199], v[216:219], v[88:91]
    v_mfma_f32_16x16x32_bf16 v[96:99], v[200:203], v[208:211], v[96:99]
    v_mfma_f32_16x16x32_bf16 v[100:103], v[200:203], v[212:215], v[100:103]
    v_mfma_f32_16x16x32_bf16 v[108:111], v[200:203], v[220:223], v[108:111]
    v_mfma_f32_16x16x32_bf16 v[104:107], v[200:203], v[216:219], v[104:107]
    v_mfma_f32_16x16x32_bf16 v[112:115], v[204:207], v[208:211], v[112:115]
    v_mfma_f32_16x16x32_bf16 v[116:119], v[204:207], v[212:215], v[116:119]
    v_mfma_f32_16x16x32_bf16 v[124:127], v[204:207], v[220:223], v[124:127]
    v_mfma_f32_16x16x32_bf16 v[120:123], v[204:207], v[216:219], v[120:123]
    v_xor_b32 v245, 0, v242
    v_add_u32 v224, 0x0, v245
    v_add_u32 v228, 0x1c000, v245
    v_xor_b32 v245, 64, v242
    v_add_u32 v225, 0x0, v245
    v_add_u32 v229, 0x1c000, v245
    v_xor_b32 v245, 128, v242
    v_add_u32 v226, 0x0, v245
    v_add_u32 v230, 0x1c000, v245
    v_xor_b32 v245, 192, v242
    v_add_u32 v227, 0x0, v245
    v_add_u32 v231, 0x1c000, v245
    s_nop 4
    ds_read_b128 v[192:195], v224 offset:0
    ds_read_b128 v[196:199], v225 offset:0
    ds_read_b128 v[200:203], v226 offset:0
    ds_read_b128 v[204:207], v227 offset:0
    v_cvt_pk_bf16_f32 v128, v0, v1
    v_cvt_pk_bf16_f32 v129, v2, v3
    v_cvt_pk_bf16_f32 v130, v16, v17
    v_cvt_pk_bf16_f32 v131, v18, v19
    v_cvt_pk_bf16_f32 v132, v4, v5
    v_cvt_pk_bf16_f32 v133, v6, v7
    v_cvt_pk_bf16_f32 v134, v20, v21
    v_cvt_pk_bf16_f32 v135, v22, v23
    v_cvt_pk_bf16_f32 v136, v8, v9
    v_cvt_pk_bf16_f32 v137, v10, v11
    v_cvt_pk_bf16_f32 v138, v24, v25
    v_cvt_pk_bf16_f32 v139, v26, v27
    v_cvt_pk_bf16_f32 v140, v12, v13
    v_cvt_pk_bf16_f32 v141, v14, v15
    v_cvt_pk_bf16_f32 v142, v28, v29
    v_cvt_pk_bf16_f32 v143, v30, v31
    v_cvt_pk_bf16_f32 v144, v32, v33
    v_cvt_pk_bf16_f32 v145, v34, v35
    v_cvt_pk_bf16_f32 v146, v48, v49
    v_cvt_pk_bf16_f32 v147, v50, v51
    v_cvt_pk_bf16_f32 v148, v36, v37
    v_cvt_pk_bf16_f32 v149, v38, v39
    v_cvt_pk_bf16_f32 v150, v52, v53
    v_cvt_pk_bf16_f32 v151, v54, v55
    v_cvt_pk_bf16_f32 v152, v40, v41
    v_cvt_pk_bf16_f32 v153, v42, v43
    v_cvt_pk_bf16_f32 v154, v56, v57
    v_cvt_pk_bf16_f32 v155, v58, v59
    v_cvt_pk_bf16_f32 v156, v44, v45
    v_cvt_pk_bf16_f32 v157, v46, v47
    v_cvt_pk_bf16_f32 v158, v60, v61
    v_cvt_pk_bf16_f32 v159, v62, v63
    v_cvt_pk_bf16_f32 v160, v64, v65
    v_cvt_pk_bf16_f32 v161, v66, v67
    v_cvt_pk_bf16_f32 v162, v80, v81
    v_cvt_pk_bf16_f32 v163, v82, v83
    v_cvt_pk_bf16_f32 v164, v68, v69
    v_cvt_pk_bf16_f32 v165, v70, v71
    v_cvt_pk_bf16_f32 v166, v84, v85
    v_cvt_pk_bf16_f32 v167, v86, v87
    v_cvt_pk_bf16_f32 v168, v72, v73
    v_cvt_pk_bf16_f32 v169, v74, v75
    v_cvt_pk_bf16_f32 v170, v88, v89
    v_cvt_pk_bf16_f32 v171, v90, v91
    v_cvt_pk_bf16_f32 v172, v76, v77
    v_cvt_pk_bf16_f32 v173, v78, v79
    v_cvt_pk_bf16_f32 v174, v92, v93
    v_cvt_pk_bf16_f32 v175, v94, v95
    v_cvt_pk_bf16_f32 v176, v96, v97
    v_cvt_pk_bf16_f32 v177, v98, v99
    v_cvt_pk_bf16_f32 v178, v112, v113
    v_cvt_pk_bf16_f32 v179, v114, v115
    v_cvt_pk_bf16_f32 v180, v100, v101
    v_cvt_pk_bf16_f32 v181, v102, v103
    v_cvt_pk_bf16_f32 v182, v116, v117
    v_cvt_pk_bf16_f32 v183, v118, v119
    v_cvt_pk_bf16_f32 v184, v104, v105
    v_cvt_pk_bf16_f32 v185, v106, v107
    v_cvt_pk_bf16_f32 v186, v120, v121
    v_cvt_pk_bf16_f32 v187, v122, v123
    v_cvt_pk_bf16_f32 v188, v108, v109
    v_cvt_pk_bf16_f32 v189, v110, v111
    v_cvt_pk_bf16_f32 v190, v124, v125
    v_cvt_pk_bf16_f32 v191, v126, v127
    s_waitcnt lgkmcnt(0)
    v_mfma_f32_16x16x32_bf16 v[0:3], v[192:195], v[128:131], 0
    ds_read_b128 v[208:211], v228 offset:0
    v_mfma_f32_16x16x32_bf16 v[4:7], v[192:195], v[132:135], 0
    ds_read_b128 v[212:215], v229 offset:0
    v_mfma_f32_16x16x32_bf16 v[8:11], v[192:195], v[136:139], 0
    ds_read_b128 v[216:219], v230 offset:0
    v_mfma_f32_16x16x32_bf16 v[12:15], v[192:195], v[140:143], 0
    ds_read_b128 v[220:223], v231 offset:0
    v_mfma_f32_16x16x32_bf16 v[0:3], v[196:199], v[144:147], v[0:3]
    v_mfma_f32_16x16x32_bf16 v[4:7], v[196:199], v[148:151], v[4:7]
    v_mfma_f32_16x16x32_bf16 v[8:11], v[196:199], v[152:155], v[8:11]
    v_mfma_f32_16x16x32_bf16 v[12:15], v[196:199], v[156:159], v[12:15]
    v_mfma_f32_16x16x32_bf16 v[0:3], v[200:203], v[160:163], v[0:3]
    v_mfma_f32_16x16x32_bf16 v[4:7], v[200:203], v[164:167], v[4:7]
    v_mfma_f32_16x16x32_bf16 v[8:11], v[200:203], v[168:171], v[8:11]
    v_mfma_f32_16x16x32_bf16 v[12:15], v[200:203], v[172:175], v[12:15]
    v_mfma_f32_16x16x32_bf16 v[0:3], v[204:207], v[176:179], v[0:3]
    v_mfma_f32_16x16x32_bf16 v[4:7], v[204:207], v[180:183], v[4:7]
    v_mfma_f32_16x16x32_bf16 v[8:11], v[204:207], v[184:187], v[8:11]
    v_mfma_f32_16x16x32_bf16 v[12:15], v[204:207], v[188:191], v[12:15]
    s_waitcnt lgkmcnt(0)
    v_cndmask_b32 v208, v208, v243, s[62:63]
    v_cndmask_b32 v209, v209, v243, s[62:63]
    v_cndmask_b32 v210, v210, v243, s[62:63]
    v_cndmask_b32 v211, v211, v243, s[62:63]
    v_cndmask_b32 v212, v212, v243, s[62:63]
    v_cndmask_b32 v213, v213, v243, s[62:63]
    v_cndmask_b32 v214, v214, v243, s[62:63]
    v_cndmask_b32 v215, v215, v243, s[62:63]
    v_cndmask_b32 v216, v216, v243, s[62:63]
    v_cndmask_b32 v217, v217, v243, s[62:63]
    v_cndmask_b32 v218, v218, v243, s[62:63]
    v_cndmask_b32 v219, v219, v243, s[62:63]
    v_cndmask_b32 v220, v220, v243, s[62:63]
    v_cndmask_b32 v221, v221, v243, s[62:63]
    v_cndmask_b32 v222, v222, v243, s[62:63]
    v_cndmask_b32 v223, v223, v243, s[62:63]
    s_nop 1
    v_mfma_f32_16x16x32_bf16 v[16:19], v[208:211], v[128:131], 0
    ds_read_b128 v[192:195], v224 offset:4096
    v_mfma_f32_16x16x32_bf16 v[20:23], v[208:211], v[132:135], 0
    ds_read_b128 v[196:199], v225 offset:4096
    v_mfma_f32_16x16x32_bf16 v[24:27], v[208:211], v[136:139], 0
    ds_read_b128 v[200:203], v226 offset:4096
    v_mfma_f32_16x16x32_bf16 v[28:31], v[208:211], v[140:143], 0
    ds_read_b128 v[204:207], v227 offset:4096
    v_mfma_f32_16x16x32_bf16 v[16:19], v[212:215], v[144:147], v[16:19]
    v_mfma_f32_16x16x32_bf16 v[20:23], v[212:215], v[148:151], v[20:23]
    v_mfma_f32_16x16x32_bf16 v[24:27], v[212:215], v[152:155], v[24:27]
    v_mfma_f32_16x16x32_bf16 v[28:31], v[212:215], v[156:159], v[28:31]
    v_mfma_f32_16x16x32_bf16 v[16:19], v[216:219], v[160:163], v[16:19]
    v_mfma_f32_16x16x32_bf16 v[20:23], v[216:219], v[164:167], v[20:23]
    v_mfma_f32_16x16x32_bf16 v[24:27], v[216:219], v[168:171], v[24:27]
    v_mfma_f32_16x16x32_bf16 v[28:31], v[216:219], v[172:175], v[28:31]
    v_mfma_f32_16x16x32_bf16 v[16:19], v[220:223], v[176:179], v[16:19]
    v_mfma_f32_16x16x32_bf16 v[20:23], v[220:223], v[180:183], v[20:23]
    v_mfma_f32_16x16x32_bf16 v[24:27], v[220:223], v[184:187], v[24:27]
    v_mfma_f32_16x16x32_bf16 v[28:31], v[220:223], v[188:191], v[28:31]
    s_waitcnt lgkmcnt(0)
    v_mfma_f32_16x16x32_bf16 v[32:35], v[192:195], v[128:131], 0
    ds_read_b128 v[208:211], v228 offset:4096
    v_mfma_f32_16x16x32_bf16 v[36:39], v[192:195], v[132:135], 0
    ds_read_b128 v[212:215], v229 offset:4096
    v_mfma_f32_16x16x32_bf16 v[40:43], v[192:195], v[136:139], 0
    ds_read_b128 v[216:219], v230 offset:4096
    v_mfma_f32_16x16x32_bf16 v[44:47], v[192:195], v[140:143], 0
    ds_read_b128 v[220:223], v231 offset:4096
    v_mfma_f32_16x16x32_bf16 v[32:35], v[196:199], v[144:147], v[32:35]
    v_cvt_pk_bf16_f32 v248, v0, v16
    v_mfma_f32_16x16x32_bf16 v[36:39], v[196:199], v[148:151], v[36:39]
    v_cvt_pk_bf16_f32 v249, v8, v24
    v_mfma_f32_16x16x32_bf16 v[40:43], v[196:199], v[152:155], v[40:43]
    v_cvt_pk_bf16_f32 v250, v1, v17
    v_mfma_f32_16x16x32_bf16 v[44:47], v[196:199], v[156:159], v[44:47]
    v_cvt_pk_bf16_f32 v251, v9, v25
    v_mfma_f32_16x16x32_bf16 v[32:35], v[200:203], v[160:163], v[32:35]
    s_add_u32 s29, s28, 0
    v_mfma_f32_16x16x32_bf16 v[36:39], v[200:203], v[164:167], v[36:39]
    buffer_store_dwordx4 v[248:251], v244, s[52:55], s29 offen offset:0 sc1
    v_mfma_f32_16x16x32_bf16 v[40:43], v[200:203], v[168:171], v[40:43]
    v_cvt_pk_bf16_f32 v252, v4, v20
    v_mfma_f32_16x16x32_bf16 v[44:47], v[200:203], v[172:175], v[44:47]
    v_cvt_pk_bf16_f32 v253, v12, v28
    v_mfma_f32_16x16x32_bf16 v[32:35], v[204:207], v[176:179], v[32:35]
    v_cvt_pk_bf16_f32 v254, v5, v21
    v_mfma_f32_16x16x32_bf16 v[36:39], v[204:207], v[180:183], v[36:39]
    v_cvt_pk_bf16_f32 v255, v13, v29
    v_mfma_f32_16x16x32_bf16 v[40:43], v[204:207], v[184:187], v[40:43]
    buffer_store_dwordx4 v[252:255], v244, s[52:55], s29 offen offset:256 sc1
    v_mfma_f32_16x16x32_bf16 v[44:47], v[204:207], v[188:191], v[44:47]
    s_waitcnt lgkmcnt(0)
    v_mfma_f32_16x16x32_bf16 v[48:51], v[208:211], v[128:131], 0
    ds_read_b128 v[192:195], v224 offset:8192
    v_mfma_f32_16x16x32_bf16 v[52:55], v[208:211], v[132:135], 0
    ds_read_b128 v[196:199], v225 offset:8192
    v_mfma_f32_16x16x32_bf16 v[56:59], v[208:211], v[136:139], 0
    ds_read_b128 v[200:203], v226 offset:8192
    v_mfma_f32_16x16x32_bf16 v[60:63], v[208:211], v[140:143], 0
    ds_read_b128 v[204:207], v227 offset:8192
    v_mfma_f32_16x16x32_bf16 v[48:51], v[212:215], v[144:147], v[48:51]
    v_cvt_pk_bf16_f32 v248, v2, v18
    v_mfma_f32_16x16x32_bf16 v[52:55], v[212:215], v[148:151], v[52:55]
    v_cvt_pk_bf16_f32 v249, v10, v26
    v_mfma_f32_16x16x32_bf16 v[56:59], v[212:215], v[152:155], v[56:59]
    v_cvt_pk_bf16_f32 v250, v3, v19
    v_mfma_f32_16x16x32_bf16 v[60:63], v[212:215], v[156:159], v[60:63]
    v_cvt_pk_bf16_f32 v251, v11, v27
    v_mfma_f32_16x16x32_bf16 v[48:51], v[216:219], v[160:163], v[48:51]
    s_add_u32 s29, s28, 65536
    v_mfma_f32_16x16x32_bf16 v[52:55], v[216:219], v[164:167], v[52:55]
    buffer_store_dwordx4 v[248:251], v244, s[52:55], s29 offen offset:0 sc1
    v_mfma_f32_16x16x32_bf16 v[56:59], v[216:219], v[168:171], v[56:59]
    v_cvt_pk_bf16_f32 v252, v6, v22
    v_mfma_f32_16x16x32_bf16 v[60:63], v[216:219], v[172:175], v[60:63]
    v_cvt_pk_bf16_f32 v253, v14, v30
    v_mfma_f32_16x16x32_bf16 v[48:51], v[220:223], v[176:179], v[48:51]
    v_cvt_pk_bf16_f32 v254, v7, v23
    v_mfma_f32_16x16x32_bf16 v[52:55], v[220:223], v[180:183], v[52:55]
    v_cvt_pk_bf16_f32 v255, v15, v31
    v_mfma_f32_16x16x32_bf16 v[56:59], v[220:223], v[184:187], v[56:59]
    buffer_store_dwordx4 v[252:255], v244, s[52:55], s29 offen offset:256 sc1
    v_mfma_f32_16x16x32_bf16 v[60:63], v[220:223], v[188:191], v[60:63]
    s_waitcnt lgkmcnt(0)
    v_mfma_f32_16x16x32_bf16 v[64:67], v[192:195], v[128:131], 0
    ds_read_b128 v[208:211], v228 offset:8192
    v_mfma_f32_16x16x32_bf16 v[68:71], v[192:195], v[132:135], 0
    ds_read_b128 v[212:215], v229 offset:8192
    v_mfma_f32_16x16x32_bf16 v[72:75], v[192:195], v[136:139], 0
    ds_read_b128 v[216:219], v230 offset:8192
    v_mfma_f32_16x16x32_bf16 v[76:79], v[192:195], v[140:143], 0
    ds_read_b128 v[220:223], v231 offset:8192
    v_mfma_f32_16x16x32_bf16 v[64:67], v[196:199], v[144:147], v[64:67]
    v_cvt_pk_bf16_f32 v248, v32, v48
    v_mfma_f32_16x16x32_bf16 v[68:71], v[196:199], v[148:151], v[68:71]
    v_cvt_pk_bf16_f32 v249, v40, v56
    v_mfma_f32_16x16x32_bf16 v[72:75], v[196:199], v[152:155], v[72:75]
    v_cvt_pk_bf16_f32 v250, v33, v49
    v_mfma_f32_16x16x32_bf16 v[76:79], v[196:199], v[156:159], v[76:79]
    v_cvt_pk_bf16_f32 v251, v41, v57
    v_mfma_f32_16x16x32_bf16 v[64:67], v[200:203], v[160:163], v[64:67]
    s_add_u32 s29, s28, 524288
    v_mfma_f32_16x16x32_bf16 v[68:71], v[200:203], v[164:167], v[68:71]
    buffer_store_dwordx4 v[248:251], v244, s[52:55], s29 offen offset:0 sc1
    v_mfma_f32_16x16x32_bf16 v[72:75], v[200:203], v[168:171], v[72:75]
    v_cvt_pk_bf16_f32 v252, v36, v52
    v_mfma_f32_16x16x32_bf16 v[76:79], v[200:203], v[172:175], v[76:79]
    v_cvt_pk_bf16_f32 v253, v44, v60
    v_mfma_f32_16x16x32_bf16 v[64:67], v[204:207], v[176:179], v[64:67]
    v_cvt_pk_bf16_f32 v254, v37, v53
    v_mfma_f32_16x16x32_bf16 v[68:71], v[204:207], v[180:183], v[68:71]
    v_cvt_pk_bf16_f32 v255, v45, v61
    v_mfma_f32_16x16x32_bf16 v[72:75], v[204:207], v[184:187], v[72:75]
    buffer_store_dwordx4 v[252:255], v244, s[52:55], s29 offen offset:256 sc1
    v_mfma_f32_16x16x32_bf16 v[76:79], v[204:207], v[188:191], v[76:79]
    s_waitcnt lgkmcnt(0)
    v_mfma_f32_16x16x32_bf16 v[80:83], v[208:211], v[128:131], 0
    ds_read_b128 v[192:195], v224 offset:12288
    v_mfma_f32_16x16x32_bf16 v[84:87], v[208:211], v[132:135], 0
    ds_read_b128 v[196:199], v225 offset:12288
    v_mfma_f32_16x16x32_bf16 v[88:91], v[208:211], v[136:139], 0
    ds_read_b128 v[200:203], v226 offset:12288
    v_mfma_f32_16x16x32_bf16 v[92:95], v[208:211], v[140:143], 0
    ds_read_b128 v[204:207], v227 offset:12288
    v_mfma_f32_16x16x32_bf16 v[80:83], v[212:215], v[144:147], v[80:83]
    v_cvt_pk_bf16_f32 v248, v34, v50
    v_mfma_f32_16x16x32_bf16 v[84:87], v[212:215], v[148:151], v[84:87]
    v_cvt_pk_bf16_f32 v249, v42, v58
    v_mfma_f32_16x16x32_bf16 v[88:91], v[212:215], v[152:155], v[88:91]
    v_cvt_pk_bf16_f32 v250, v35, v51
    v_mfma_f32_16x16x32_bf16 v[92:95], v[212:215], v[156:159], v[92:95]
    v_cvt_pk_bf16_f32 v251, v43, v59
    v_mfma_f32_16x16x32_bf16 v[80:83], v[216:219], v[160:163], v[80:83]
    s_add_u32 s29, s28, 589824
    v_mfma_f32_16x16x32_bf16 v[84:87], v[216:219], v[164:167], v[84:87]
    buffer_store_dwordx4 v[248:251], v244, s[52:55], s29 offen offset:0 sc1
    v_mfma_f32_16x16x32_bf16 v[88:91], v[216:219], v[168:171], v[88:91]
    v_cvt_pk_bf16_f32 v252, v38, v54
    v_mfma_f32_16x16x32_bf16 v[92:95], v[216:219], v[172:175], v[92:95]
    v_cvt_pk_bf16_f32 v253, v46, v62
    v_mfma_f32_16x16x32_bf16 v[80:83], v[220:223], v[176:179], v[80:83]
    v_cvt_pk_bf16_f32 v254, v39, v55
    v_mfma_f32_16x16x32_bf16 v[84:87], v[220:223], v[180:183], v[84:87]
    v_cvt_pk_bf16_f32 v255, v47, v63
    v_mfma_f32_16x16x32_bf16 v[88:91], v[220:223], v[184:187], v[88:91]
    buffer_store_dwordx4 v[252:255], v244, s[52:55], s29 offen offset:256 sc1
    v_mfma_f32_16x16x32_bf16 v[92:95], v[220:223], v[188:191], v[92:95]
    s_waitcnt lgkmcnt(0)
    v_mfma_f32_16x16x32_bf16 v[96:99], v[192:195], v[128:131], 0
    ds_read_b128 v[208:211], v228 offset:12288
    v_mfma_f32_16x16x32_bf16 v[100:103], v[192:195], v[132:135], 0
    ds_read_b128 v[212:215], v229 offset:12288
    v_mfma_f32_16x16x32_bf16 v[104:107], v[192:195], v[136:139], 0
    ds_read_b128 v[216:219], v230 offset:12288
    v_mfma_f32_16x16x32_bf16 v[108:111], v[192:195], v[140:143], 0
    ds_read_b128 v[220:223], v231 offset:12288
    v_mfma_f32_16x16x32_bf16 v[96:99], v[196:199], v[144:147], v[96:99]
    v_cvt_pk_bf16_f32 v248, v64, v80
    v_mfma_f32_16x16x32_bf16 v[100:103], v[196:199], v[148:151], v[100:103]
    v_cvt_pk_bf16_f32 v249, v72, v88
    v_mfma_f32_16x16x32_bf16 v[104:107], v[196:199], v[152:155], v[104:107]
    v_cvt_pk_bf16_f32 v250, v65, v81
    v_mfma_f32_16x16x32_bf16 v[108:111], v[196:199], v[156:159], v[108:111]
    v_cvt_pk_bf16_f32 v251, v73, v89
    v_mfma_f32_16x16x32_bf16 v[96:99], v[200:203], v[160:163], v[96:99]
    s_add_u32 s29, s28, 1048576
    v_mfma_f32_16x16x32_bf16 v[100:103], v[200:203], v[164:167], v[100:103]
    buffer_store_dwordx4 v[248:251], v244, s[52:55], s29 offen offset:0 sc1
    v_mfma_f32_16x16x32_bf16 v[104:107], v[200:203], v[168:171], v[104:107]
    v_cvt_pk_bf16_f32 v252, v68, v84
    v_mfma_f32_16x16x32_bf16 v[108:111], v[200:203], v[172:175], v[108:111]
    v_cvt_pk_bf16_f32 v253, v76, v92
    v_mfma_f32_16x16x32_bf16 v[96:99], v[204:207], v[176:179], v[96:99]
    v_cvt_pk_bf16_f32 v254, v69, v85
    v_mfma_f32_16x16x32_bf16 v[100:103], v[204:207], v[180:183], v[100:103]
    v_cvt_pk_bf16_f32 v255, v77, v93
    v_mfma_f32_16x16x32_bf16 v[104:107], v[204:207], v[184:187], v[104:107]
    buffer_store_dwordx4 v[252:255], v244, s[52:55], s29 offen offset:256 sc1
    v_mfma_f32_16x16x32_bf16 v[108:111], v[204:207], v[188:191], v[108:111]
    s_waitcnt lgkmcnt(0)
    v_mfma_f32_16x16x32_bf16 v[112:115], v[208:211], v[128:131], 0
    s_nop 0
    v_mfma_f32_16x16x32_bf16 v[116:119], v[208:211], v[132:135], 0
    s_nop 0
    v_mfma_f32_16x16x32_bf16 v[120:123], v[208:211], v[136:139], 0
    s_nop 0
    v_mfma_f32_16x16x32_bf16 v[124:127], v[208:211], v[140:143], 0
    s_nop 0
    v_mfma_f32_16x16x32_bf16 v[112:115], v[212:215], v[144:147], v[112:115]
    v_cvt_pk_bf16_f32 v248, v66, v82
    v_mfma_f32_16x16x32_bf16 v[116:119], v[212:215], v[148:151], v[116:119]
    v_cvt_pk_bf16_f32 v249, v74, v90
    v_mfma_f32_16x16x32_bf16 v[120:123], v[212:215], v[152:155], v[120:123]
    v_cvt_pk_bf16_f32 v250, v67, v83
    v_mfma_f32_16x16x32_bf16 v[124:127], v[212:215], v[156:159], v[124:127]
    v_cvt_pk_bf16_f32 v251, v75, v91
    v_mfma_f32_16x16x32_bf16 v[112:115], v[216:219], v[160:163], v[112:115]
    s_add_u32 s29, s28, 1114112
    v_mfma_f32_16x16x32_bf16 v[116:119], v[216:219], v[164:167], v[116:119]
    buffer_store_dwordx4 v[248:251], v244, s[52:55], s29 offen offset:0 sc1
    v_mfma_f32_16x16x32_bf16 v[120:123], v[216:219], v[168:171], v[120:123]
    v_cvt_pk_bf16_f32 v252, v70, v86
    v_mfma_f32_16x16x32_bf16 v[124:127], v[216:219], v[172:175], v[124:127]
    v_cvt_pk_bf16_f32 v253, v78, v94
    v_mfma_f32_16x16x32_bf16 v[112:115], v[220:223], v[176:179], v[112:115]
    v_cvt_pk_bf16_f32 v254, v71, v87
    v_mfma_f32_16x16x32_bf16 v[116:119], v[220:223], v[180:183], v[116:119]
    v_cvt_pk_bf16_f32 v255, v79, v95
    v_mfma_f32_16x16x32_bf16 v[120:123], v[220:223], v[184:187], v[120:123]
    buffer_store_dwordx4 v[252:255], v244, s[52:55], s29 offen offset:256 sc1
    v_mfma_f32_16x16x32_bf16 v[124:127], v[220:223], v[188:191], v[124:127]
    s_nop 7
    v_cvt_pk_bf16_f32 v248, v96, v112
    v_cvt_pk_bf16_f32 v249, v104, v120
    v_cvt_pk_bf16_f32 v250, v97, v113
    v_cvt_pk_bf16_f32 v251, v105, v121
    s_add_u32 s29, s28, 1572864
    buffer_store_dwordx4 v[248:251], v244, s[52:55], s29 offen offset:0 sc1
    v_cvt_pk_bf16_f32 v252, v100, v116
    v_cvt_pk_bf16_f32 v253, v108, v124
    v_cvt_pk_bf16_f32 v254, v101, v117
    v_cvt_pk_bf16_f32 v255, v109, v125
    buffer_store_dwordx4 v[252:255], v244, s[52:55], s29 offen offset:256 sc1
    s_nop 1
    v_cvt_pk_bf16_f32 v248, v98, v114
    v_cvt_pk_bf16_f32 v249, v106, v122
    v_cvt_pk_bf16_f32 v250, v99, v115
    v_cvt_pk_bf16_f32 v251, v107, v123
    s_add_u32 s29, s28, 1638400
    buffer_store_dwordx4 v[248:251], v244, s[52:55], s29 offen offset:0 sc1
    v_cvt_pk_bf16_f32 v252, v102, v118
    v_cvt_pk_bf16_f32 v253, v110, v126
    v_cvt_pk_bf16_f32 v254, v103, v119
    v_cvt_pk_bf16_f32 v255, v111, v127
    buffer_store_dwordx4 v[252:255], v244, s[52:55], s29 offen offset:256 sc1
    s_nop 1
c2:
    s_mov_b32 s24, s76
    s_mov_b32 s25, s75
    v_mbcnt_lo_u32_b32 v1, -1, 0
    v_mbcnt_hi_u32_b32 v1, -1, v1
    v_and_b32 v2, 15, v1
    v_lshrrev_b32 v3, 4, v1
    s_and_b32 s26, s3, 1
    s_lshl_b32 s26, s26, 1
    s_lshr_b32 s27, s3, 1
    s_mul_i32 s28, s26, 16
    s_add_u32 s28, s28, s24
    s_mul_i32 s23, s27, 16
    s_add_u32 s23, s23, s28
    v_lshlrev_b32 v252, 4, v1
    s_mul_i32 s28, s28, 57344
    s_lshl_b32 s26, s27, 11
    s_add_u32 s28, s28, s26
    s_add_u32 s29, s28, 917504
    v_lshrrev_b32 v16, 2, v2
    v_lshl_add_u32 v16, v3, 2, v16
    v_bfe_u32 v17, v16, 1, 2
    v_lshlrev_b32 v17, 5, v17
    v_lshl_add_u32 v17, v16, 7, v17
    v_and_b32 v16, 3, v2
    v_lshl_add_u32 v17, v16, 3, v17
    s_lshl_b32 s26, s27, 13
    v_add_u32 v240, s26, v17
    v_xor_b32 v241, 32, v240
    v_xor_b32 v242, 64, v240
    v_xor_b32 v243, 96, v240
    v_add_u32 v244, 0x10000, v240
    v_add_u32 v245, 0x10000, v241
    v_add_u32 v246, 0x10000, v242
    v_add_u32 v247, 0x10000, v243
    v_add_u32 v248, 0x20000, v240
    v_add_u32 v249, 0x20000, v241
    v_add_u32 v250, 0x20000, v242
    v_add_u32 v251, 0x20000, v243
    v_lshlrev_b32 v8, 7, v2
    v_add_u32 v8, s23, v8
    v_lshlrev_b32 v15, 3, v3
    v_lshl_add_u32 v15, v8, 10, v15
    s_lshl_b32 s26, s25, 7
    v_add_u32 v253, s26, v15
    s_lshl_b32 s26, s3, 12
    s_add_u32 s26, s26, 114688
    v_add_u32 v254, s26, v252
    s_lshl_b32 s47, 511, s101
    s_lshr_b32 s44, s47, 14
    s_or_b32 s47, s47, s44
    s_mov_b32 s40, s66
    s_and_b32 s41, s67, 0xffff
    s_mov_b32 s42, 0x100
    s_mov_b32 s43, 0x20000
    v_lshlrev_b32 v229, 3, v1
    v_mov_b32 v228, 0
    s_mov_b64 exec, 0x3fff
    buffer_load_dwordx2 v[224:225], v228, s[40:43], 0 offen sc0 sc1
    buffer_load_dwordx2 v[230:231], v229, s[52:55], s99 offen sc0 sc1
    s_waitcnt vmcnt(0)
    s_barrier
    v_cmp_ne_u64 vcc, v[230:231], v[224:225]
    v_cmp_eq_u64 s[44:45], 0, v[224:225]
    s_nop 3
    s_or_b32 s46, vcc_lo, s44
    s_and_b32 s44, s46, s47
    s_cbranch_scc0 poll1_d
    buffer_load_dwordx2 v[224:225], v228, s[40:43], 0 offen sc0 sc1
    s_mov_b32 s100, 0x40000
    s_mov_b32 exec_lo, 0x3fff
    s_mov_b32 exec_hi, 0x0
poll1:
    buffer_load_dwordx2 v[230:231], v229, s[52:55], s99 offen sc0 sc1
    s_waitcnt vmcnt(0)
    v_cmp_ne_u64 vcc, v[230:231], v[224:225]
    s_sub_u32 s100, s100, 1
    s_cbranch_scc1 poll1_d
    s_nop 3
    s_mov_b32 s46, vcc_lo
    s_and_b32 s44, s46, s47
    s_cbranch_scc0 poll1_d
    s_sleep 2
    s_branch poll1
poll1_d:
    s_mov_b64 exec, -1
    s_add_u32 s44, s101, 0
    s_sub_u32 s45, s44, 14
    s_cselect_b32 s44, s44, s45
    s_lshl_b32 s44, s44, 12
    s_add_u32 s20, s28, s44
    buffer_load_dwordx4 v[80:83], v252, s[36:39], s20 offen offset:0 sc1
    s_add_u32 s21, s29, s44
    buffer_load_dwordx4 v[84:87], v252, s[36:39], s21 offen offset:0 sc1
    buffer_load_dwordx4 v[88:91], v252, s[36:39], s20 offen offset:1024 sc1
    buffer_load_dwordx4 v[92:95], v252, s[36:39], s21 offen offset:1024 sc1
    s_add_u32 s44, s101, 1
    s_sub_u32 s45, s44, 14
    s_cselect_b32 s44, s44, s45
    s_lshl_b32 s44, s44, 12
    s_add_u32 s20, s28, s44
    buffer_load_dwordx4 v[96:99], v252, s[36:39], s20 offen offset:0 sc1
    s_add_u32 s21, s29, s44
    buffer_load_dwordx4 v[100:103], v252, s[36:39], s21 offen offset:0 sc1
    buffer_load_dwordx4 v[104:107], v252, s[36:39], s20 offen offset:1024 sc1
    buffer_load_dwordx4 v[108:111], v252, s[36:39], s21 offen offset:1024 sc1
    ds_read_b64_tr_b16 v[32:33], v248 offset:0
    ds_read_b64_tr_b16 v[34:35], v248 offset:2048
    ds_read_b64_tr_b16 v[36:37], v249 offset:0
    ds_read_b64_tr_b16 v[38:39], v249 offset:2048
    ds_read_b64_tr_b16 v[40:41], v250 offset:0
    ds_read_b64_tr_b16 v[42:43], v250 offset:2048
    ds_read_b64_tr_b16 v[44:45], v251 offset:0
    ds_read_b64_tr_b16 v[46:47], v251 offset:2048
    ds_read_b64_tr_b16 v[48:49], v248 offset:4096
    ds_read_b64_tr_b16 v[50:51], v248 offset:6144
    ds_read_b64_tr_b16 v[52:53], v249 offset:4096
    ds_read_b64_tr_b16 v[54:55], v249 offset:6144
    ds_read_b64_tr_b16 v[56:57], v250 offset:4096
    ds_read_b64_tr_b16 v[58:59], v250 offset:6144
    ds_read_b64_tr_b16 v[60:61], v251 offset:4096
    ds_read_b64_tr_b16 v[62:63], v251 offset:6144
    s_add_u32 s44, s101, 2
    s_sub_u32 s45, s44, 14
    s_cselect_b32 s44, s44, s45
    s_lshl_b32 s44, s44, 12
    s_add_u32 s20, s28, s44
    buffer_load_dwordx4 v[112:115], v252, s[36:39], s20 offen offset:0 sc1
    s_add_u32 s21, s29, s44
    buffer_load_dwordx4 v[116:119], v252, s[36:39], s21 offen offset:0 sc1
    buffer_load_dwordx4 v[120:123], v252, s[36:39], s20 offen offset:1024 sc1
    buffer_load_dwordx4 v[124:127], v252, s[36:39], s21 offen offset:1024 sc1
    s_add_u32 s44, s101, 3
    s_sub_u32 s45, s44, 14
    s_cselect_b32 s44, s44, s45
    s_lshl_b32 s44, s44, 12
    s_add_u32 s20, s28, s44
    buffer_load_dwordx4 v[128:131], v252, s[36:39], s20 offen offset:0 sc1
    s_add_u32 s21, s29, s44
    buffer_load_dwordx4 v[132:135], v252, s[36:39], s21 offen offset:0 sc1
    buffer_load_dwordx4 v[136:139], v252, s[36:39], s20 offen offset:1024 sc1
    buffer_load_dwordx4 v[140:143], v252, s[36:39], s21 offen offset:1024 sc1
    s_add_u32 s44, s101, 4
    s_sub_u32 s45, s44, 14
    s_cselect_b32 s44, s44, s45
    s_lshl_b32 s44, s44, 12
    s_add_u32 s20, s28, s44
    buffer_load_dwordx4 v[144:147], v252, s[36:39], s20 offen offset:0 sc1
    s_add_u32 s21, s29, s44
    buffer_load_dwordx4 v[148:151], v252, s[36:39], s21 offen offset:0 sc1
    buffer_load_dwordx4 v[152:155], v252, s[36:39], s20 offen offset:1024 sc1
    buffer_load_dwordx4 v[156:159], v252, s[36:39], s21 offen offset:1024 sc1
    s_add_u32 s44, s101, 5
    s_sub_u32 s45, s44, 14
    s_cselect_b32 s44, s44, s45
    s_lshl_b32 s44, s44, 12
    s_add_u32 s20, s28, s44
    buffer_load_dwordx4 v[160:163], v252, s[36:39], s20 offen offset:0 sc1
    s_add_u32 s21, s29, s44
    buffer_load_dwordx4 v[164:167], v252, s[36:39], s21 offen offset:0 sc1
    buffer_load_dwordx4 v[168:171], v252, s[36:39], s20 offen offset:1024 sc1
    buffer_load_dwordx4 v[172:175], v252, s[36:39], s21 offen offset:1024 sc1
    s_add_u32 s44, s101, 6
    s_sub_u32 s45, s44, 14
    s_cselect_b32 s44, s44, s45
    s_lshl_b32 s44, s44, 12
    s_add_u32 s20, s28, s44
    buffer_load_dwordx4 v[176:179], v252, s[36:39], s20 offen offset:0 sc1
    s_add_u32 s21, s29, s44
    buffer_load_dwordx4 v[180:183], v252, s[36:39], s21 offen offset:0 sc1
    buffer_load_dwordx4 v[184:187], v252, s[36:39], s20 offen offset:1024 sc1
    buffer_load_dwordx4 v[188:191], v252, s[36:39], s21 offen offset:1024 sc1
    s_add_u32 s44, s101, 7
    s_sub_u32 s45, s44, 14
    s_cselect_b32 s44, s44, s45
    s_lshl_b32 s44, s44, 12
    s_add_u32 s20, s28, s44
    buffer_load_dwordx4 v[192:195], v252, s[36:39], s20 offen offset:0 sc1
    s_add_u32 s21, s29, s44
    buffer_load_dwordx4 v[196:199], v252, s[36:39], s21 offen offset:0 sc1
    buffer_load_dwordx4 v[200:203], v252, s[36:39], s20 offen offset:1024 sc1
    buffer_load_dwordx4 v[204:207], v252, s[36:39], s21 offen offset:1024 sc1
    s_add_u32 s44, s101, 8
    s_sub_u32 s45, s44, 14
    s_cselect_b32 s44, s44, s45
    s_lshl_b32 s44, s44, 12
    s_add_u32 s20, s28, s44
    buffer_load_dwordx4 v[208:211], v252, s[36:39], s20 offen offset:0 sc1
    s_add_u32 s21, s29, s44
    buffer_load_dwordx4 v[212:215], v252, s[36:39], s21 offen offset:0 sc1
    buffer_load_dwordx4 v[216:219], v252, s[36:39], s20 offen offset:1024 sc1
    buffer_load_dwordx4 v[220:223], v252, s[36:39], s21 offen offset:1024 sc1
    s_waitcnt lgkmcnt(8)
    s_waitcnt vmcnt(34)
    v_mfma_f32_16x16x32_bf16 v[0:3], v[32:35], v[80:83], 0
    ds_read_b64_tr_b16 v[64:65], v240 offset:49152
    v_mfma_f32_16x16x32_bf16 v[16:19], v[32:35], v[84:87], 0
    ds_read_b64_tr_b16 v[66:67], v240 offset:51200
    v_mfma_f32_16x16x32_bf16 v[4:7], v[36:39], v[80:83], 0
    ds_read_b64_tr_b16 v[68:69], v241 offset:49152
    v_mfma_f32_16x16x32_bf16 v[20:23], v[36:39], v[84:87], 0
    ds_read_b64_tr_b16 v[70:71], v241 offset:51200
    v_mfma_f32_16x16x32_bf16 v[8:11], v[40:43], v[80:83], 0
    ds_read_b64_tr_b16 v[72:73], v242 offset:49152
    v_mfma_f32_16x16x32_bf16 v[24:27], v[40:43], v[84:87], 0
    ds_read_b64_tr_b16 v[74:75], v242 offset:51200
    v_mfma_f32_16x16x32_bf16 v[12:15], v[44:47], v[80:83], 0
    ds_read_b64_tr_b16 v[76:77], v243 offset:49152
    v_mfma_f32_16x16x32_bf16 v[28:31], v[44:47], v[84:87], 0
    ds_read_b64_tr_b16 v[78:79], v243 offset:51200
    s_waitcnt lgkmcnt(8)
    s_waitcnt vmcnt(32)
    v_mfma_f32_16x16x32_bf16 v[0:3], v[48:51], v[88:91], v[0:3]
    ds_read_b64_tr_b16 v[32:33], v240 offset:53248
    v_mfma_f32_16x16x32_bf16 v[16:19], v[48:51], v[92:95], v[16:19]
    ds_read_b64_tr_b16 v[34:35], v240 offset:55296
    v_mfma_f32_16x16x32_bf16 v[4:7], v[52:55], v[88:91], v[4:7]
    ds_read_b64_tr_b16 v[36:37], v241 offset:53248
    v_mfma_f32_16x16x32_bf16 v[20:23], v[52:55], v[92:95], v[20:23]
    ds_read_b64_tr_b16 v[38:39], v241 offset:55296
    v_mfma_f32_16x16x32_bf16 v[8:11], v[56:59], v[88:91], v[8:11]
    ds_read_b64_tr_b16 v[40:41], v242 offset:53248
    v_mfma_f32_16x16x32_bf16 v[24:27], v[56:59], v[92:95], v[24:27]
    ds_read_b64_tr_b16 v[42:43], v242 offset:55296
    v_mfma_f32_16x16x32_bf16 v[12:15], v[60:63], v[88:91], v[12:15]
    ds_read_b64_tr_b16 v[44:45], v243 offset:53248
    v_mfma_f32_16x16x32_bf16 v[28:31], v[60:63], v[92:95], v[28:31]
    ds_read_b64_tr_b16 v[46:47], v243 offset:55296
    s_waitcnt lgkmcnt(8)
    s_waitcnt vmcnt(30)
    v_mfma_f32_16x16x32_bf16 v[0:3], v[64:67], v[96:99], v[0:3]
    ds_read_b64_tr_b16 v[48:49], v240 offset:16384
    v_mfma_f32_16x16x32_bf16 v[16:19], v[64:67], v[100:103], v[16:19]
    ds_read_b64_tr_b16 v[50:51], v240 offset:18432
    v_mfma_f32_16x16x32_bf16 v[4:7], v[68:71], v[96:99], v[4:7]
    ds_read_b64_tr_b16 v[52:53], v241 offset:16384
    v_mfma_f32_16x16x32_bf16 v[20:23], v[68:71], v[100:103], v[20:23]
    ds_read_b64_tr_b16 v[54:55], v241 offset:18432
    v_mfma_f32_16x16x32_bf16 v[8:11], v[72:75], v[96:99], v[8:11]
    ds_read_b64_tr_b16 v[56:57], v242 offset:16384
    v_mfma_f32_16x16x32_bf16 v[24:27], v[72:75], v[100:103], v[24:27]
    ds_read_b64_tr_b16 v[58:59], v242 offset:18432
    v_mfma_f32_16x16x32_bf16 v[12:15], v[76:79], v[96:99], v[12:15]
    ds_read_b64_tr_b16 v[60:61], v243 offset:16384
    v_mfma_f32_16x16x32_bf16 v[28:31], v[76:79], v[100:103], v[28:31]
    ds_read_b64_tr_b16 v[62:63], v243 offset:18432
    s_waitcnt lgkmcnt(8)
    s_waitcnt vmcnt(28)
    v_mfma_f32_16x16x32_bf16 v[0:3], v[32:35], v[104:107], v[0:3]
    ds_read_b64_tr_b16 v[64:65], v240 offset:20480
    v_mfma_f32_16x16x32_bf16 v[16:19], v[32:35], v[108:111], v[16:19]
    ds_read_b64_tr_b16 v[66:67], v240 offset:22528
    v_mfma_f32_16x16x32_bf16 v[4:7], v[36:39], v[104:107], v[4:7]
    ds_read_b64_tr_b16 v[68:69], v241 offset:20480
    v_mfma_f32_16x16x32_bf16 v[20:23], v[36:39], v[108:111], v[20:23]
    ds_read_b64_tr_b16 v[70:71], v241 offset:22528
    v_mfma_f32_16x16x32_bf16 v[8:11], v[40:43], v[104:107], v[8:11]
    ds_read_b64_tr_b16 v[72:73], v242 offset:20480
    v_mfma_f32_16x16x32_bf16 v[24:27], v[40:43], v[108:111], v[24:27]
    ds_read_b64_tr_b16 v[74:75], v242 offset:22528
    v_mfma_f32_16x16x32_bf16 v[12:15], v[44:47], v[104:107], v[12:15]
    ds_read_b64_tr_b16 v[76:77], v243 offset:20480
    v_mfma_f32_16x16x32_bf16 v[28:31], v[44:47], v[108:111], v[28:31]
    ds_read_b64_tr_b16 v[78:79], v243 offset:22528
    s_waitcnt lgkmcnt(8)
    s_waitcnt vmcnt(26)
    v_mfma_f32_16x16x32_bf16 v[0:3], v[48:51], v[112:115], v[0:3]
    ds_read_b64_tr_b16 v[32:33], v240 offset:32768
    v_mfma_f32_16x16x32_bf16 v[16:19], v[48:51], v[116:119], v[16:19]
    ds_read_b64_tr_b16 v[34:35], v240 offset:34816
    v_mfma_f32_16x16x32_bf16 v[4:7], v[52:55], v[112:115], v[4:7]
    ds_read_b64_tr_b16 v[36:37], v241 offset:32768
    v_mfma_f32_16x16x32_bf16 v[20:23], v[52:55], v[116:119], v[20:23]
    ds_read_b64_tr_b16 v[38:39], v241 offset:34816
    v_mfma_f32_16x16x32_bf16 v[8:11], v[56:59], v[112:115], v[8:11]
    ds_read_b64_tr_b16 v[40:41], v242 offset:32768
    v_mfma_f32_16x16x32_bf16 v[24:27], v[56:59], v[116:119], v[24:27]
    ds_read_b64_tr_b16 v[42:43], v242 offset:34816
    v_mfma_f32_16x16x32_bf16 v[12:15], v[60:63], v[112:115], v[12:15]
    ds_read_b64_tr_b16 v[44:45], v243 offset:32768
    v_mfma_f32_16x16x32_bf16 v[28:31], v[60:63], v[116:119], v[28:31]
    ds_read_b64_tr_b16 v[46:47], v243 offset:34816
    s_waitcnt lgkmcnt(8)
    s_waitcnt vmcnt(24)
    v_mfma_f32_16x16x32_bf16 v[0:3], v[64:67], v[120:123], v[0:3]
    ds_read_b64_tr_b16 v[48:49], v240 offset:36864
    v_mfma_f32_16x16x32_bf16 v[16:19], v[64:67], v[124:127], v[16:19]
    ds_read_b64_tr_b16 v[50:51], v240 offset:38912
    v_mfma_f32_16x16x32_bf16 v[4:7], v[68:71], v[120:123], v[4:7]
    ds_read_b64_tr_b16 v[52:53], v241 offset:36864
    v_mfma_f32_16x16x32_bf16 v[20:23], v[68:71], v[124:127], v[20:23]
    ds_read_b64_tr_b16 v[54:55], v241 offset:38912
    v_mfma_f32_16x16x32_bf16 v[8:11], v[72:75], v[120:123], v[8:11]
    ds_read_b64_tr_b16 v[56:57], v242 offset:36864
    v_mfma_f32_16x16x32_bf16 v[24:27], v[72:75], v[124:127], v[24:27]
    ds_read_b64_tr_b16 v[58:59], v242 offset:38912
    v_mfma_f32_16x16x32_bf16 v[12:15], v[76:79], v[120:123], v[12:15]
    ds_read_b64_tr_b16 v[60:61], v243 offset:36864
    v_mfma_f32_16x16x32_bf16 v[28:31], v[76:79], v[124:127], v[28:31]
    ds_read_b64_tr_b16 v[62:63], v243 offset:38912
    s_waitcnt lgkmcnt(8)
    s_waitcnt vmcnt(22)
    v_mfma_f32_16x16x32_bf16 v[0:3], v[32:35], v[128:131], v[0:3]
    ds_read_b64_tr_b16 v[64:65], v244 offset:32768
    v_mfma_f32_16x16x32_bf16 v[16:19], v[32:35], v[132:135], v[16:19]
    ds_read_b64_tr_b16 v[66:67], v244 offset:34816
    v_mfma_f32_16x16x32_bf16 v[4:7], v[36:39], v[128:131], v[4:7]
    ds_read_b64_tr_b16 v[68:69], v245 offset:32768
    v_mfma_f32_16x16x32_bf16 v[20:23], v[36:39], v[132:135], v[20:23]
    ds_read_b64_tr_b16 v[70:71], v245 offset:34816
    v_mfma_f32_16x16x32_bf16 v[8:11], v[40:43], v[128:131], v[8:11]
    ds_read_b64_tr_b16 v[72:73], v246 offset:32768
    v_mfma_f32_16x16x32_bf16 v[24:27], v[40:43], v[132:135], v[24:27]
    ds_read_b64_tr_b16 v[74:75], v246 offset:34816
    v_mfma_f32_16x16x32_bf16 v[12:15], v[44:47], v[128:131], v[12:15]
    ds_read_b64_tr_b16 v[76:77], v247 offset:32768
    v_mfma_f32_16x16x32_bf16 v[28:31], v[44:47], v[132:135], v[28:31]
    ds_read_b64_tr_b16 v[78:79], v247 offset:34816
    s_waitcnt lgkmcnt(8)
    s_waitcnt vmcnt(20)
    v_mfma_f32_16x16x32_bf16 v[0:3], v[48:51], v[136:139], v[0:3]
    ds_read_b64_tr_b16 v[32:33], v244 offset:36864
    v_mfma_f32_16x16x32_bf16 v[16:19], v[48:51], v[140:143], v[16:19]
    ds_read_b64_tr_b16 v[34:35], v244 offset:38912
    v_mfma_f32_16x16x32_bf16 v[4:7], v[52:55], v[136:139], v[4:7]
    ds_read_b64_tr_b16 v[36:37], v245 offset:36864
    v_mfma_f32_16x16x32_bf16 v[20:23], v[52:55], v[140:143], v[20:23]
    ds_read_b64_tr_b16 v[38:39], v245 offset:38912
    v_mfma_f32_16x16x32_bf16 v[8:11], v[56:59], v[136:139], v[8:11]
    ds_read_b64_tr_b16 v[40:41], v246 offset:36864
    v_mfma_f32_16x16x32_bf16 v[24:27], v[56:59], v[140:143], v[24:27]
    ds_read_b64_tr_b16 v[42:43], v246 offset:38912
    v_mfma_f32_16x16x32_bf16 v[12:15], v[60:63], v[136:139], v[12:15]
    ds_read_b64_tr_b16 v[44:45], v247 offset:36864
    v_mfma_f32_16x16x32_bf16 v[28:31], v[60:63], v[140:143], v[28:31]
    ds_read_b64_tr_b16 v[46:47], v247 offset:38912
    s_waitcnt lgkmcnt(8)
    s_waitcnt vmcnt(18)
    v_mfma_f32_16x16x32_bf16 v[0:3], v[64:67], v[144:147], v[0:3]
    ds_read_b64_tr_b16 v[48:49], v244 offset:0
    v_mfma_f32_16x16x32_bf16 v[16:19], v[64:67], v[148:151], v[16:19]
    ds_read_b64_tr_b16 v[50:51], v244 offset:2048
    v_mfma_f32_16x16x32_bf16 v[4:7], v[68:71], v[144:147], v[4:7]
    ds_read_b64_tr_b16 v[52:53], v245 offset:0
    v_mfma_f32_16x16x32_bf16 v[20:23], v[68:71], v[148:151], v[20:23]
    ds_read_b64_tr_b16 v[54:55], v245 offset:2048
    v_mfma_f32_16x16x32_bf16 v[8:11], v[72:75], v[144:147], v[8:11]
    ds_read_b64_tr_b16 v[56:57], v246 offset:0
    v_mfma_f32_16x16x32_bf16 v[24:27], v[72:75], v[148:151], v[24:27]
    ds_read_b64_tr_b16 v[58:59], v246 offset:2048
    v_mfma_f32_16x16x32_bf16 v[12:15], v[76:79], v[144:147], v[12:15]
    ds_read_b64_tr_b16 v[60:61], v247 offset:0
    v_mfma_f32_16x16x32_bf16 v[28:31], v[76:79], v[148:151], v[28:31]
    ds_read_b64_tr_b16 v[62:63], v247 offset:2048
    s_waitcnt lgkmcnt(8)
    s_waitcnt vmcnt(16)
    v_mfma_f32_16x16x32_bf16 v[0:3], v[32:35], v[152:155], v[0:3]
    ds_read_b64_tr_b16 v[64:65], v244 offset:4096
    v_mfma_f32_16x16x32_bf16 v[16:19], v[32:35], v[156:159], v[16:19]
    ds_read_b64_tr_b16 v[66:67], v244 offset:6144
    v_mfma_f32_16x16x32_bf16 v[4:7], v[36:39], v[152:155], v[4:7]
    ds_read_b64_tr_b16 v[68:69], v245 offset:4096
    v_mfma_f32_16x16x32_bf16 v[20:23], v[36:39], v[156:159], v[20:23]
    ds_read_b64_tr_b16 v[70:71], v245 offset:6144
    v_mfma_f32_16x16x32_bf16 v[8:11], v[40:43], v[152:155], v[8:11]
    ds_read_b64_tr_b16 v[72:73], v246 offset:4096
    v_mfma_f32_16x16x32_bf16 v[24:27], v[40:43], v[156:159], v[24:27]
    ds_read_b64_tr_b16 v[74:75], v246 offset:6144
    v_mfma_f32_16x16x32_bf16 v[12:15], v[44:47], v[152:155], v[12:15]
    ds_read_b64_tr_b16 v[76:77], v247 offset:4096
    v_mfma_f32_16x16x32_bf16 v[28:31], v[44:47], v[156:159], v[28:31]
    ds_read_b64_tr_b16 v[78:79], v247 offset:6144
    s_lshl_b32 s47, 16383, s101
    s_lshr_b32 s44, s47, 14
    s_or_b32 s47, s47, s44
    s_and_b32 s44, s46, s47
    s_cbranch_scc0 poll1c_d
    s_mov_b32 s100, 0x40000
    s_mov_b32 exec_lo, 0x3fff
    s_mov_b32 exec_hi, 0x0
poll1c:
    buffer_load_dwordx2 v[230:231], v229, s[52:55], s99 offen sc0 sc1
    s_waitcnt vmcnt(0)
    v_cmp_ne_u64 vcc, v[230:231], v[224:225]
    s_sub_u32 s100, s100, 1
    s_cbranch_scc1 poll1c_d
    s_nop 3
    s_mov_b32 s46, vcc_lo
    s_and_b32 s44, s46, s47
    s_cbranch_scc0 poll1c_d
    s_sleep 2
    s_branch poll1c
poll1c_d:
    s_mov_b64 exec, -1
    s_waitcnt lgkmcnt(8)
    s_barrier
    s_waitcnt vmcnt(14)
    v_mfma_f32_16x16x32_bf16 v[0:3], v[48:51], v[160:163], v[0:3]
    ds_read_b64_tr_b16 v[32:33], v244 offset:16384
    v_mfma_f32_16x16x32_bf16 v[16:19], v[48:51], v[164:167], v[16:19]
    ds_read_b64_tr_b16 v[34:35], v244 offset:18432
    v_mfma_f32_16x16x32_bf16 v[4:7], v[52:55], v[160:163], v[4:7]
    ds_read_b64_tr_b16 v[36:37], v245 offset:16384
    v_mfma_f32_16x16x32_bf16 v[20:23], v[52:55], v[164:167], v[20:23]
    ds_read_b64_tr_b16 v[38:39], v245 offset:18432
    s_add_u32 s44, s101, 9
    s_sub_u32 s45, s44, 14
    s_cselect_b32 s44, s44, s45
    s_lshl_b32 s44, s44, 12
    s_add_u32 s20, s28, s44
    buffer_load_dwordx4 v[224:227], v252, s[36:39], s20 offen offset:0 sc1
    v_mfma_f32_16x16x32_bf16 v[8:11], v[56:59], v[160:163], v[8:11]
    ds_read_b64_tr_b16 v[40:41], v246 offset:16384
    v_mfma_f32_16x16x32_bf16 v[24:27], v[56:59], v[164:167], v[24:27]
    ds_read_b64_tr_b16 v[42:43], v246 offset:18432
    s_add_u32 s21, s29, s44
    buffer_load_dwordx4 v[228:231], v252, s[36:39], s21 offen offset:0 sc1
    v_mfma_f32_16x16x32_bf16 v[12:15], v[60:63], v[160:163], v[12:15]
    ds_read_b64_tr_b16 v[44:45], v247 offset:16384
    v_mfma_f32_16x16x32_bf16 v[28:31], v[60:63], v[164:167], v[28:31]
    ds_read_b64_tr_b16 v[46:47], v247 offset:18432
    buffer_load_dwordx4 v[232:235], v252, s[36:39], s20 offen offset:1024 sc1
    s_waitcnt lgkmcnt(8)
    s_waitcnt vmcnt(15)
    v_mfma_f32_16x16x32_bf16 v[0:3], v[64:67], v[168:171], v[0:3]
    ds_read_b64_tr_b16 v[48:49], v244 offset:20480
    v_mfma_f32_16x16x32_bf16 v[16:19], v[64:67], v[172:175], v[16:19]
    ds_read_b64_tr_b16 v[50:51], v244 offset:22528
    v_mfma_f32_16x16x32_bf16 v[4:7], v[68:71], v[168:171], v[4:7]
    ds_read_b64_tr_b16 v[52:53], v245 offset:20480
    v_mfma_f32_16x16x32_bf16 v[20:23], v[68:71], v[172:175], v[20:23]
    ds_read_b64_tr_b16 v[54:55], v245 offset:22528
    buffer_load_dwordx4 v[236:239], v252, s[36:39], s21 offen offset:1024 sc1
    v_mfma_f32_16x16x32_bf16 v[8:11], v[72:75], v[168:171], v[8:11]
    ds_read_b64_tr_b16 v[56:57], v246 offset:20480
    v_mfma_f32_16x16x32_bf16 v[24:27], v[72:75], v[172:175], v[24:27]
    ds_read_b64_tr_b16 v[58:59], v246 offset:22528
    s_add_u32 s44, s101, 10
    s_sub_u32 s45, s44, 14
    s_cselect_b32 s44, s44, s45
    s_lshl_b32 s44, s44, 12
    s_add_u32 s20, s28, s44
    buffer_load_dwordx4 v[80:83], v252, s[36:39], s20 offen offset:0 sc1
    v_mfma_f32_16x16x32_bf16 v[12:15], v[76:79], v[168:171], v[12:15]
    ds_read_b64_tr_b16 v[60:61], v247 offset:20480
    v_mfma_f32_16x16x32_bf16 v[28:31], v[76:79], v[172:175], v[28:31]
    ds_read_b64_tr_b16 v[62:63], v247 offset:22528
    s_add_u32 s21, s29, s44
    buffer_load_dwordx4 v[84:87], v252, s[36:39], s21 offen offset:0 sc1
    s_waitcnt lgkmcnt(8)
    s_waitcnt vmcnt(16)
    v_mfma_f32_16x16x32_bf16 v[0:3], v[32:35], v[176:179], v[0:3]
    ds_read_b64_tr_b16 v[64:65], v248 offset:16384
    v_mfma_f32_16x16x32_bf16 v[16:19], v[32:35], v[180:183], v[16:19]
    ds_read_b64_tr_b16 v[66:67], v248 offset:18432
    v_mfma_f32_16x16x32_bf16 v[4:7], v[36:39], v[176:179], v[4:7]
    ds_read_b64_tr_b16 v[68:69], v249 offset:16384
    v_mfma_f32_16x16x32_bf16 v[20:23], v[36:39], v[180:183], v[20:23]
    ds_read_b64_tr_b16 v[70:71], v249 offset:18432
    buffer_load_dwordx4 v[88:91], v252, s[36:39], s20 offen offset:1024 sc1
    v_mfma_f32_16x16x32_bf16 v[8:11], v[40:43], v[176:179], v[8:11]
    ds_read_b64_tr_b16 v[72:73], v250 offset:16384
    v_mfma_f32_16x16x32_bf16 v[24:27], v[40:43], v[180:183], v[24:27]
    ds_read_b64_tr_b16 v[74:75], v250 offset:18432
    buffer_load_dwordx4 v[92:95], v252, s[36:39], s21 offen offset:1024 sc1
    v_mfma_f32_16x16x32_bf16 v[12:15], v[44:47], v[176:179], v[12:15]
    ds_read_b64_tr_b16 v[76:77], v251 offset:16384
    v_mfma_f32_16x16x32_bf16 v[28:31], v[44:47], v[180:183], v[28:31]
    ds_read_b64_tr_b16 v[78:79], v251 offset:18432
    s_add_u32 s44, s101, 11
    s_sub_u32 s45, s44, 14
    s_cselect_b32 s44, s44, s45
    s_lshl_b32 s44, s44, 12
    s_add_u32 s20, s28, s44
    buffer_load_dwordx4 v[96:99], v252, s[36:39], s20 offen offset:0 sc1
    s_waitcnt lgkmcnt(8)
    s_waitcnt vmcnt(17)
    v_mfma_f32_16x16x32_bf16 v[0:3], v[48:51], v[184:187], v[0:3]
    ds_read_b64_tr_b16 v[32:33], v248 offset:20480
    v_mfma_f32_16x16x32_bf16 v[16:19], v[48:51], v[188:191], v[16:19]
    ds_read_b64_tr_b16 v[34:35], v248 offset:22528
    v_mfma_f32_16x16x32_bf16 v[4:7], v[52:55], v[184:187], v[4:7]
    ds_read_b64_tr_b16 v[36:37], v249 offset:20480
    v_mfma_f32_16x16x32_bf16 v[20:23], v[52:55], v[188:191], v[20:23]
    ds_read_b64_tr_b16 v[38:39], v249 offset:22528
    s_add_u32 s21, s29, s44
    buffer_load_dwordx4 v[100:103], v252, s[36:39], s21 offen offset:0 sc1
    v_mfma_f32_16x16x32_bf16 v[8:11], v[56:59], v[184:187], v[8:11]
    ds_read_b64_tr_b16 v[40:41], v250 offset:20480
    v_mfma_f32_16x16x32_bf16 v[24:27], v[56:59], v[188:191], v[24:27]
    ds_read_b64_tr_b16 v[42:43], v250 offset:22528
    buffer_load_dwordx4 v[104:107], v252, s[36:39], s20 offen offset:1024 sc1
    v_mfma_f32_16x16x32_bf16 v[12:15], v[60:63], v[184:187], v[12:15]
    ds_read_b64_tr_b16 v[44:45], v251 offset:20480
    v_mfma_f32_16x16x32_bf16 v[28:31], v[60:63], v[188:191], v[28:31]
    ds_read_b64_tr_b16 v[46:47], v251 offset:22528
    buffer_load_dwordx4 v[108:111], v252, s[36:39], s21 offen offset:1024 sc1
    s_waitcnt lgkmcnt(8)
    s_waitcnt vmcnt(18)
    v_mfma_f32_16x16x32_bf16 v[0:3], v[64:67], v[192:195], v[0:3]
    ds_read_b64_tr_b16 v[48:49], v240 offset:0
    v_mfma_f32_16x16x32_bf16 v[16:19], v[64:67], v[196:199], v[16:19]
    ds_read_b64_tr_b16 v[50:51], v240 offset:2048
    v_mfma_f32_16x16x32_bf16 v[4:7], v[68:71], v[192:195], v[4:7]
    ds_read_b64_tr_b16 v[52:53], v241 offset:0
    v_mfma_f32_16x16x32_bf16 v[20:23], v[68:71], v[196:199], v[20:23]
    ds_read_b64_tr_b16 v[54:55], v241 offset:2048
    s_add_u32 s44, s101, 12
    s_sub_u32 s45, s44, 14
    s_cselect_b32 s44, s44, s45
    s_lshl_b32 s44, s44, 12
    s_add_u32 s20, s28, s44
    buffer_load_dwordx4 v[112:115], v252, s[36:39], s20 offen offset:0 sc1
    v_mfma_f32_16x16x32_bf16 v[8:11], v[72:75], v[192:195], v[8:11]
    ds_read_b64_tr_b16 v[56:57], v242 offset:0
    v_mfma_f32_16x16x32_bf16 v[24:27], v[72:75], v[196:199], v[24:27]
    ds_read_b64_tr_b16 v[58:59], v242 offset:2048
    s_add_u32 s21, s29, s44
    buffer_load_dwordx4 v[116:119], v252, s[36:39], s21 offen offset:0 sc1
    v_mfma_f32_16x16x32_bf16 v[12:15], v[76:79], v[192:195], v[12:15]
    ds_read_b64_tr_b16 v[60:61], v243 offset:0
    v_mfma_f32_16x16x32_bf16 v[28:31], v[76:79], v[196:199], v[28:31]
    ds_read_b64_tr_b16 v[62:63], v243 offset:2048
    buffer_load_dwordx4 v[120:123], v252, s[36:39], s20 offen offset:1024 sc1
    s_waitcnt lgkmcnt(8)
    s_waitcnt vmcnt(19)
    v_mfma_f32_16x16x32_bf16 v[0:3], v[32:35], v[200:203], v[0:3]
    ds_read_b64_tr_b16 v[64:65], v240 offset:4096
    v_mfma_f32_16x16x32_bf16 v[16:19], v[32:35], v[204:207], v[16:19]
    ds_read_b64_tr_b16 v[66:67], v240 offset:6144
    v_mfma_f32_16x16x32_bf16 v[4:7], v[36:39], v[200:203], v[4:7]
    ds_read_b64_tr_b16 v[68:69], v241 offset:4096
    v_mfma_f32_16x16x32_bf16 v[20:23], v[36:39], v[204:207], v[20:23]
    ds_read_b64_tr_b16 v[70:71], v241 offset:6144
    buffer_load_dwordx4 v[124:127], v252, s[36:39], s21 offen offset:1024 sc1
    v_mfma_f32_16x16x32_bf16 v[8:11], v[40:43], v[200:203], v[8:11]
    ds_read_b64_tr_b16 v[72:73], v242 offset:4096
    v_mfma_f32_16x16x32_bf16 v[24:27], v[40:43], v[204:207], v[24:27]
    ds_read_b64_tr_b16 v[74:75], v242 offset:6144
    s_add_u32 s44, s101, 13
    s_sub_u32 s45, s44, 14
    s_cselect_b32 s44, s44, s45
    s_lshl_b32 s44, s44, 12
    s_add_u32 s20, s28, s44
    buffer_load_dwordx4 v[128:131], v252, s[36:39], s20 offen offset:0 sc1
    v_mfma_f32_16x16x32_bf16 v[12:15], v[44:47], v[200:203], v[12:15]
    ds_read_b64_tr_b16 v[76:77], v243 offset:4096
    v_mfma_f32_16x16x32_bf16 v[28:31], v[44:47], v[204:207], v[28:31]
    ds_read_b64_tr_b16 v[78:79], v243 offset:6144
    s_add_u32 s21, s29, s44
    buffer_load_dwordx4 v[132:135], v252, s[36:39], s21 offen offset:0 sc1
    s_waitcnt lgkmcnt(8)
    s_barrier
    s_waitcnt vmcnt(20)
    v_mfma_f32_16x16x32_bf16 v[0:3], v[48:51], v[208:211], v[0:3]
    ds_read_b64_tr_b16 v[32:33], v248 offset:0
    v_mfma_f32_16x16x32_bf16 v[16:19], v[48:51], v[212:215], v[16:19]
    ds_read_b64_tr_b16 v[34:35], v248 offset:2048
    v_mfma_f32_16x16x32_bf16 v[4:7], v[52:55], v[208:211], v[4:7]
    ds_read_b64_tr_b16 v[36:37], v249 offset:0
    v_mfma_f32_16x16x32_bf16 v[20:23], v[52:55], v[212:215], v[20:23]
    ds_read_b64_tr_b16 v[38:39], v249 offset:2048
    buffer_load_dwordx4 v[136:139], v252, s[36:39], s20 offen offset:1024 sc1
    v_mfma_f32_16x16x32_bf16 v[8:11], v[56:59], v[208:211], v[8:11]
    ds_read_b64_tr_b16 v[40:41], v250 offset:0
    v_mfma_f32_16x16x32_bf16 v[24:27], v[56:59], v[212:215], v[24:27]
    ds_read_b64_tr_b16 v[42:43], v250 offset:2048
    buffer_load_dwordx4 v[140:143], v252, s[36:39], s21 offen offset:1024 sc1
    v_mfma_f32_16x16x32_bf16 v[12:15], v[60:63], v[208:211], v[12:15]
    ds_read_b64_tr_b16 v[44:45], v251 offset:0
    v_mfma_f32_16x16x32_bf16 v[28:31], v[60:63], v[212:215], v[28:31]
    ds_read_b64_tr_b16 v[46:47], v251 offset:2048
    s_waitcnt lgkmcnt(8)
    s_waitcnt vmcnt(20)
    v_mfma_f32_16x16x32_bf16 v[0:3], v[64:67], v[216:219], v[0:3]
    ds_read_b64_tr_b16 v[48:49], v248 offset:4096
    v_mfma_f32_16x16x32_bf16 v[16:19], v[64:67], v[220:223], v[16:19]
    ds_read_b64_tr_b16 v[50:51], v248 offset:6144
    v_mfma_f32_16x16x32_bf16 v[4:7], v[68:71], v[216:219], v[4:7]
    ds_read_b64_tr_b16 v[52:53], v249 offset:4096
    v_mfma_f32_16x16x32_bf16 v[20:23], v[68:71], v[220:223], v[20:23]
    ds_read_b64_tr_b16 v[54:55], v249 offset:6144
    v_mfma_f32_16x16x32_bf16 v[8:11], v[72:75], v[216:219], v[8:11]
    ds_read_b64_tr_b16 v[56:57], v250 offset:4096
    v_mfma_f32_16x16x32_bf16 v[24:27], v[72:75], v[220:223], v[24:27]
    ds_read_b64_tr_b16 v[58:59], v250 offset:6144
    v_mfma_f32_16x16x32_bf16 v[12:15], v[76:79], v[216:219], v[12:15]
    ds_read_b64_tr_b16 v[60:61], v251 offset:4096
    v_mfma_f32_16x16x32_bf16 v[28:31], v[76:79], v[220:223], v[28:31]
    ds_read_b64_tr_b16 v[62:63], v251 offset:6144
    s_waitcnt lgkmcnt(8)
    s_waitcnt vmcnt(18)
    v_mfma_f32_16x16x32_bf16 v[0:3], v[32:35], v[224:227], v[0:3]
    ds_read_b64_tr_b16 v[64:65], v240 offset:49152
    v_mfma_f32_16x16x32_bf16 v[16:19], v[32:35], v[228:231], v[16:19]
    ds_read_b64_tr_b16 v[66:67], v240 offset:51200
    v_mfma_f32_16x16x32_bf16 v[4:7], v[36:39], v[224:227], v[4:7]
    ds_read_b64_tr_b16 v[68:69], v241 offset:49152
    v_mfma_f32_16x16x32_bf16 v[20:23], v[36:39], v[228:231], v[20:23]
    ds_read_b64_tr_b16 v[70:71], v241 offset:51200
    v_mfma_f32_16x16x32_bf16 v[8:11], v[40:43], v[224:227], v[8:11]
    ds_read_b64_tr_b16 v[72:73], v242 offset:49152
    v_mfma_f32_16x16x32_bf16 v[24:27], v[40:43], v[228:231], v[24:27]
    ds_read_b64_tr_b16 v[74:75], v242 offset:51200
    v_mfma_f32_16x16x32_bf16 v[12:15], v[44:47], v[224:227], v[12:15]
    ds_read_b64_tr_b16 v[76:77], v243 offset:49152
    v_mfma_f32_16x16x32_bf16 v[28:31], v[44:47], v[228:231], v[28:31]
    ds_read_b64_tr_b16 v[78:79], v243 offset:51200
    s_waitcnt lgkmcnt(8)
    s_waitcnt vmcnt(16)
    v_mfma_f32_16x16x32_bf16 v[0:3], v[48:51], v[232:235], v[0:3]
    ds_read_b64_tr_b16 v[32:33], v240 offset:53248
    v_mfma_f32_16x16x32_bf16 v[16:19], v[48:51], v[236:239], v[16:19]
    ds_read_b64_tr_b16 v[34:35], v240 offset:55296
    v_mfma_f32_16x16x32_bf16 v[4:7], v[52:55], v[232:235], v[4:7]
    ds_read_b64_tr_b16 v[36:37], v241 offset:53248
    v_mfma_f32_16x16x32_bf16 v[20:23], v[52:55], v[236:239], v[20:23]
    ds_read_b64_tr_b16 v[38:39], v241 offset:55296
    v_mfma_f32_16x16x32_bf16 v[8:11], v[56:59], v[232:235], v[8:11]
    ds_read_b64_tr_b16 v[40:41], v242 offset:53248
    v_mfma_f32_16x16x32_bf16 v[24:27], v[56:59], v[236:239], v[24:27]
    ds_read_b64_tr_b16 v[42:43], v242 offset:55296
    v_mfma_f32_16x16x32_bf16 v[12:15], v[60:63], v[232:235], v[12:15]
    ds_read_b64_tr_b16 v[44:45], v243 offset:53248
    v_mfma_f32_16x16x32_bf16 v[28:31], v[60:63], v[236:239], v[28:31]
    ds_read_b64_tr_b16 v[46:47], v243 offset:55296
    s_waitcnt lgkmcnt(8)
    s_waitcnt vmcnt(14)
    v_mfma_f32_16x16x32_bf16 v[0:3], v[64:67], v[80:83], v[0:3]
    ds_read_b64_tr_b16 v[48:49], v240 offset:16384
    v_mfma_f32_16x16x32_bf16 v[16:19], v[64:67], v[84:87], v[16:19]
    ds_read_b64_tr_b16 v[50:51], v240 offset:18432
    v_mfma_f32_16x16x32_bf16 v[4:7], v[68:71], v[80:83], v[4:7]
    ds_read_b64_tr_b16 v[52:53], v241 offset:16384
    v_mfma_f32_16x16x32_bf16 v[20:23], v[68:71], v[84:87], v[20:23]
    ds_read_b64_tr_b16 v[54:55], v241 offset:18432
    v_mfma_f32_16x16x32_bf16 v[8:11], v[72:75], v[80:83], v[8:11]
    ds_read_b64_tr_b16 v[56:57], v242 offset:16384
    v_mfma_f32_16x16x32_bf16 v[24:27], v[72:75], v[84:87], v[24:27]
    ds_read_b64_tr_b16 v[58:59], v242 offset:18432
    v_mfma_f32_16x16x32_bf16 v[12:15], v[76:79], v[80:83], v[12:15]
    ds_read_b64_tr_b16 v[60:61], v243 offset:16384
    v_mfma_f32_16x16x32_bf16 v[28:31], v[76:79], v[84:87], v[28:31]
    ds_read_b64_tr_b16 v[62:63], v243 offset:18432
    s_waitcnt lgkmcnt(8)
    s_waitcnt vmcnt(12)
    v_mfma_f32_16x16x32_bf16 v[0:3], v[32:35], v[88:91], v[0:3]
    ds_read_b64_tr_b16 v[64:65], v240 offset:20480
    v_mfma_f32_16x16x32_bf16 v[16:19], v[32:35], v[92:95], v[16:19]
    ds_read_b64_tr_b16 v[66:67], v240 offset:22528
    v_mfma_f32_16x16x32_bf16 v[4:7], v[36:39], v[88:91], v[4:7]
    ds_read_b64_tr_b16 v[68:69], v241 offset:20480
    v_mfma_f32_16x16x32_bf16 v[20:23], v[36:39], v[92:95], v[20:23]
    ds_read_b64_tr_b16 v[70:71], v241 offset:22528
    v_mfma_f32_16x16x32_bf16 v[8:11], v[40:43], v[88:91], v[8:11]
    ds_read_b64_tr_b16 v[72:73], v242 offset:20480
    v_mfma_f32_16x16x32_bf16 v[24:27], v[40:43], v[92:95], v[24:27]
    ds_read_b64_tr_b16 v[74:75], v242 offset:22528
    v_mfma_f32_16x16x32_bf16 v[12:15], v[44:47], v[88:91], v[12:15]
    ds_read_b64_tr_b16 v[76:77], v243 offset:20480
    v_mfma_f32_16x16x32_bf16 v[28:31], v[44:47], v[92:95], v[28:31]
    ds_read_b64_tr_b16 v[78:79], v243 offset:22528
    s_waitcnt lgkmcnt(8)
    s_waitcnt vmcnt(10)
    v_mfma_f32_16x16x32_bf16 v[0:3], v[48:51], v[96:99], v[0:3]
    ds_read_b64_tr_b16 v[32:33], v240 offset:32768
    v_mfma_f32_16x16x32_bf16 v[16:19], v[48:51], v[100:103], v[16:19]
    ds_read_b64_tr_b16 v[34:35], v240 offset:34816
    v_mfma_f32_16x16x32_bf16 v[4:7], v[52:55], v[96:99], v[4:7]
    ds_read_b64_tr_b16 v[36:37], v241 offset:32768
    v_mfma_f32_16x16x32_bf16 v[20:23], v[52:55], v[100:103], v[20:23]
    ds_read_b64_tr_b16 v[38:39], v241 offset:34816
    v_mfma_f32_16x16x32_bf16 v[8:11], v[56:59], v[96:99], v[8:11]
    ds_read_b64_tr_b16 v[40:41], v242 offset:32768
    v_mfma_f32_16x16x32_bf16 v[24:27], v[56:59], v[100:103], v[24:27]
    ds_read_b64_tr_b16 v[42:43], v242 offset:34816
    v_mfma_f32_16x16x32_bf16 v[12:15], v[60:63], v[96:99], v[12:15]
    ds_read_b64_tr_b16 v[44:45], v243 offset:32768
    v_mfma_f32_16x16x32_bf16 v[28:31], v[60:63], v[100:103], v[28:31]
    ds_read_b64_tr_b16 v[46:47], v243 offset:34816
    s_waitcnt lgkmcnt(8)
    s_waitcnt vmcnt(8)
    v_mfma_f32_16x16x32_bf16 v[0:3], v[64:67], v[104:107], v[0:3]
    ds_read_b64_tr_b16 v[48:49], v240 offset:36864
    v_mfma_f32_16x16x32_bf16 v[16:19], v[64:67], v[108:111], v[16:19]
    ds_read_b64_tr_b16 v[50:51], v240 offset:38912
    v_mfma_f32_16x16x32_bf16 v[4:7], v[68:71], v[104:107], v[4:7]
    ds_read_b64_tr_b16 v[52:53], v241 offset:36864
    v_mfma_f32_16x16x32_bf16 v[20:23], v[68:71], v[108:111], v[20:23]
    ds_read_b64_tr_b16 v[54:55], v241 offset:38912
    v_mfma_f32_16x16x32_bf16 v[8:11], v[72:75], v[104:107], v[8:11]
    ds_read_b64_tr_b16 v[56:57], v242 offset:36864
    v_mfma_f32_16x16x32_bf16 v[24:27], v[72:75], v[108:111], v[24:27]
    ds_read_b64_tr_b16 v[58:59], v242 offset:38912
    v_mfma_f32_16x16x32_bf16 v[12:15], v[76:79], v[104:107], v[12:15]
    ds_read_b64_tr_b16 v[60:61], v243 offset:36864
    v_mfma_f32_16x16x32_bf16 v[28:31], v[76:79], v[108:111], v[28:31]
    ds_read_b64_tr_b16 v[62:63], v243 offset:38912
    s_waitcnt lgkmcnt(8)
    s_waitcnt vmcnt(6)
    v_mfma_f32_16x16x32_bf16 v[0:3], v[32:35], v[112:115], v[0:3]
    ds_read_b64_tr_b16 v[64:65], v244 offset:32768
    v_mfma_f32_16x16x32_bf16 v[16:19], v[32:35], v[116:119], v[16:19]
    ds_read_b64_tr_b16 v[66:67], v244 offset:34816
    v_mfma_f32_16x16x32_bf16 v[4:7], v[36:39], v[112:115], v[4:7]
    ds_read_b64_tr_b16 v[68:69], v245 offset:32768
    v_mfma_f32_16x16x32_bf16 v[20:23], v[36:39], v[116:119], v[20:23]
    ds_read_b64_tr_b16 v[70:71], v245 offset:34816
    v_mfma_f32_16x16x32_bf16 v[8:11], v[40:43], v[112:115], v[8:11]
    ds_read_b64_tr_b16 v[72:73], v246 offset:32768
    v_mfma_f32_16x16x32_bf16 v[24:27], v[40:43], v[116:119], v[24:27]
    ds_read_b64_tr_b16 v[74:75], v246 offset:34816
    v_mfma_f32_16x16x32_bf16 v[12:15], v[44:47], v[112:115], v[12:15]
    ds_read_b64_tr_b16 v[76:77], v247 offset:32768
    v_mfma_f32_16x16x32_bf16 v[28:31], v[44:47], v[116:119], v[28:31]
    ds_read_b64_tr_b16 v[78:79], v247 offset:34816
    s_waitcnt lgkmcnt(8)
    s_waitcnt vmcnt(4)
    v_mfma_f32_16x16x32_bf16 v[0:3], v[48:51], v[120:123], v[0:3]
    ds_read_b64_tr_b16 v[32:33], v244 offset:36864
    v_mfma_f32_16x16x32_bf16 v[16:19], v[48:51], v[124:127], v[16:19]
    ds_read_b64_tr_b16 v[34:35], v244 offset:38912
    v_mfma_f32_16x16x32_bf16 v[4:7], v[52:55], v[120:123], v[4:7]
    ds_read_b64_tr_b16 v[36:37], v245 offset:36864
    v_mfma_f32_16x16x32_bf16 v[20:23], v[52:55], v[124:127], v[20:23]
    ds_read_b64_tr_b16 v[38:39], v245 offset:38912
    v_mfma_f32_16x16x32_bf16 v[8:11], v[56:59], v[120:123], v[8:11]
    ds_read_b64_tr_b16 v[40:41], v246 offset:36864
    v_mfma_f32_16x16x32_bf16 v[24:27], v[56:59], v[124:127], v[24:27]
    ds_read_b64_tr_b16 v[42:43], v246 offset:38912
    v_mfma_f32_16x16x32_bf16 v[12:15], v[60:63], v[120:123], v[12:15]
    ds_read_b64_tr_b16 v[44:45], v247 offset:36864
    v_mfma_f32_16x16x32_bf16 v[28:31], v[60:63], v[124:127], v[28:31]
    ds_read_b64_tr_b16 v[46:47], v247 offset:38912
    s_waitcnt lgkmcnt(8)
    s_waitcnt vmcnt(2)
    v_mfma_f32_16x16x32_bf16 v[0:3], v[64:67], v[128:131], v[0:3]
    v_mfma_f32_16x16x32_bf16 v[16:19], v[64:67], v[132:135], v[16:19]
    v_mfma_f32_16x16x32_bf16 v[4:7], v[68:71], v[128:131], v[4:7]
    v_mfma_f32_16x16x32_bf16 v[20:23], v[68:71], v[132:135], v[20:23]
    v_mfma_f32_16x16x32_bf16 v[8:11], v[72:75], v[128:131], v[8:11]
    v_mfma_f32_16x16x32_bf16 v[24:27], v[72:75], v[132:135], v[24:27]
    v_mfma_f32_16x16x32_bf16 v[12:15], v[76:79], v[128:131], v[12:15]
    v_mfma_f32_16x16x32_bf16 v[28:31], v[76:79], v[132:135], v[28:31]
    s_waitcnt lgkmcnt(0)
    s_waitcnt vmcnt(0)
    v_mfma_f32_16x16x32_bf16 v[0:3], v[32:35], v[136:139], v[0:3]
    v_mfma_f32_16x16x32_bf16 v[16:19], v[32:35], v[140:143], v[16:19]
    v_mfma_f32_16x16x32_bf16 v[4:7], v[36:39], v[136:139], v[4:7]
    v_mfma_f32_16x16x32_bf16 v[20:23], v[36:39], v[140:143], v[20:23]
    v_mfma_f32_16x16x32_bf16 v[8:11], v[40:43], v[136:139], v[8:11]
    v_mfma_f32_16x16x32_bf16 v[24:27], v[40:43], v[140:143], v[24:27]
    v_mfma_f32_16x16x32_bf16 v[12:15], v[44:47], v[136:139], v[12:15]
    v_mfma_f32_16x16x32_bf16 v[28:31], v[44:47], v[140:143], v[28:31]
    v_mbcnt_lo_u32_b32 v242, -1, 0
    v_mbcnt_hi_u32_b32 v242, -1, v242
    v_xor_b32 v255, 0x2000, v254
    s_lshl_b32 s26, s3, 12
    s_add_u32 s26, s26, 65536
    v_lshlrev_b32 v240, 4, v242
    v_add_u32 v240, s26, v240
    s_lshl_b32 s26, s3, 8
    s_add_u32 s26, s26, 81920
    v_lshlrev_b32 v241, 2, v242
    v_add_u32 v241, s26, v241
    s_cmp_eq_u32 s27, 0
    s_cbranch_scc0 k2_kh1
    ds_write_b128 v255, v[16:19] offset:0
    ds_write_b128 v255, v[20:23] offset:1024
    ds_write_b128 v255, v[24:27] offset:2048
    ds_write_b128 v255, v[28:31] offset:3072
    v_mov_b32 v112, v0
    v_mov_b32 v113, v1
    v_mov_b32 v114, v2
    v_mov_b32 v115, v3
    v_mov_b32 v116, v4
    v_mov_b32 v117, v5
    v_mov_b32 v118, v6
    v_mov_b32 v119, v7
    v_mov_b32 v120, v8
    v_mov_b32 v121, v9
    v_mov_b32 v122, v10
    v_mov_b32 v123, v11
    v_mov_b32 v124, v12
    v_mov_b32 v125, v13
    v_mov_b32 v126, v14
    v_mov_b32 v127, v15
    s_branch k2_khj
k2_kh1:
    ds_write_b128 v255, v[0:3] offset:0
    ds_write_b128 v255, v[4:7] offset:1024
    ds_write_b128 v255, v[8:11] offset:2048
    ds_write_b128 v255, v[12:15] offset:3072
    v_mov_b32 v112, v16
    v_mov_b32 v113, v17
    v_mov_b32 v114, v18
    v_mov_b32 v115, v19
    v_mov_b32 v116, v20
    v_mov_b32 v117, v21
    v_mov_b32 v118, v22
    v_mov_b32 v119, v23
    v_mov_b32 v120, v24
    v_mov_b32 v121, v25
    v_mov_b32 v122, v26
    v_mov_b32 v123, v27
    v_mov_b32 v124, v28
    v_mov_b32 v125, v29
    v_mov_b32 v126, v30
    v_mov_b32 v127, v31
k2_khj:
    s_waitcnt lgkmcnt(0)
    s_barrier
    ds_read_b32 v241, v241
    ds_read_b128 v[80:83], v254 offset:0
    ds_read_b128 v[96:99], v240 offset:0
    ds_read_b128 v[84:87], v254 offset:1024
    ds_read_b128 v[100:103], v240 offset:1024
    ds_read_b128 v[88:91], v254 offset:2048
    ds_read_b128 v[104:107], v240 offset:2048
    ds_read_b128 v[92:95], v254 offset:3072
    ds_read_b128 v[108:111], v240 offset:3072
    s_waitcnt lgkmcnt(6)
    v_add_f32 v80, v80, v112
    v_add_f32 v81, v81, v113
    v_add_f32 v82, v82, v114
    v_add_f32 v83, v83, v115
    v_fmac_f32 v96, v241, v80
    v_fmac_f32 v97, v241, v81
    v_fmac_f32 v98, v241, v82
    v_fmac_f32 v99, v241, v83
    v_cvt_pk_bf16_f32 v32, v96, v97
    v_cvt_pk_bf16_f32 v33, v98, v99
    buffer_store_dwordx2 v[32:33], v253, s[48:51], 0 offen offset:0
    s_waitcnt lgkmcnt(4)
    v_add_f32 v84, v84, v116
    v_add_f32 v85, v85, v117
    v_add_f32 v86, v86, v118
    v_add_f32 v87, v87, v119
    v_fmac_f32 v100, v241, v84
    v_fmac_f32 v101, v241, v85
    v_fmac_f32 v102, v241, v86
    v_fmac_f32 v103, v241, v87
    v_cvt_pk_bf16_f32 v34, v100, v101
    v_cvt_pk_bf16_f32 v35, v102, v103
    buffer_store_dwordx2 v[34:35], v253, s[48:51], 0 offen offset:32
    s_waitcnt lgkmcnt(2)
    v_add_f32 v88, v88, v120
    v_add_f32 v89, v89, v121
    v_add_f32 v90, v90, v122
    v_add_f32 v91, v91, v123
    v_fmac_f32 v104, v241, v88
    v_fmac_f32 v105, v241, v89
    v_fmac_f32 v106, v241, v90
    v_fmac_f32 v107, v241, v91
    v_cvt_pk_bf16_f32 v36, v104, v105
    v_cvt_pk_bf16_f32 v37, v106, v107
    buffer_store_dwordx2 v[36:37], v253, s[48:51], 0 offen offset:64
    s_waitcnt lgkmcnt(0)
    v_add_f32 v92, v92, v124
    v_add_f32 v93, v93, v125
    v_add_f32 v94, v94, v126
    v_add_f32 v95, v95, v127
    v_fmac_f32 v108, v241, v92
    v_fmac_f32 v109, v241, v93
    v_fmac_f32 v110, v241, v94
    v_fmac_f32 v111, v241, v95
    v_cvt_pk_bf16_f32 v38, v108, v109
    v_cvt_pk_bf16_f32 v39, v110, v111
    buffer_store_dwordx2 v[38:39], v253, s[48:51], 0 offen offset:96
    s_endpgm
.section .rodata,"a"
.p2align 6
.amdhsa_kernel gated_mix__spectral_fnet__swiglu_ffn__prompt_kernel
  .amdhsa_next_free_vgpr 256
  .amdhsa_next_free_sgpr 102
  .amdhsa_accum_offset 256
  .amdhsa_group_segment_fixed_size 0
  .amdhsa_kernarg_size 104
  .amdhsa_user_sgpr_count 2
  .amdhsa_user_sgpr_kernarg_segment_ptr 1
  .amdhsa_system_sgpr_workgroup_id_x 1
.end_amdhsa_kernel
```
